```python
import torch

def _softmax(x, axis=-1):
    return torch.softmax(x, dim=axis)
def _gelu(x):
    return torch.nn.functional.gelu(x, approximate="tanh")
def _silu(x):
    return torch.nn.functional.silu(x)
def _sigmoid(x):
    return torch.sigmoid(x)
def _layernorm(x, axis=-1, eps=1e-5):
    m = x.mean(dim=axis, keepdim=True)
    v = x.var(dim=axis, keepdim=True, unbiased=False)
    return (x - m) / torch.sqrt(v + eps)
def _scatter_add(tgt, idx, src, axis=0):
    return tgt.clone().index_add_(axis, idx, src)
def _segment_sum(src, seg, n):
    out = torch.zeros((n,) + src.shape[1:], dtype=src.dtype)
    return out.index_add_(0, seg, src)
def _pad(x, pw):
    flat = tuple(v for pair in reversed(pw) for v in pair)
    return torch.nn.functional.pad(x, flat)

kernel_name = 'sequential_preLN__sliding_block_cached__dense_activation_silu__decode'

def setup_inputs():

    _w = (lambda a: (lambda t: t.to(torch.bfloat16) if t.is_floating_point() else t)(torch.as_tensor(a)))
    def _A_setup():
        B, Sq, D = 2, 1, 512
        Hq, Hkv, Sk, Dh = 32, 8, 8192, 128
        assert Hq % Hkv == 0, (Hq, Hkv)
        return {
            "x": _w((lambda *s: torch.randn(*s, dtype=torch.bfloat16) * 0.05)(B, Sq, D)),
            "k_cache": _w((lambda *s: torch.randn(*s, dtype=torch.bfloat16) * 3.2)(B, Hkv, Sk, Dh)),
            "v_cache": _w((lambda *s: torch.randn(*s, dtype=torch.bfloat16) * 0.8)(B, Hkv, Sk, Dh)),
            "wq": _w((lambda *s: torch.randn(*s, dtype=torch.bfloat16) * 3.2)(D, Hq * Dh) * (D ** -0.5)),
            "wo": _w((lambda *s: torch.randn(*s, dtype=torch.bfloat16) * 0.8)(Hq * Dh, D) * ((Hq * Dh) ** -0.5)),
        }
    _A_in = _A_setup()

    def _B_setup():
        B, S, D, F = 2, 1, 512, 1792
        return {
            "x": _w((lambda *s: torch.randn(*s, dtype=torch.bfloat16) * 0.05)(B, S, D)),
            "w1": _w((lambda *s: torch.randn(*s, dtype=torch.bfloat16) * 3.2)(D, F) * (D ** -0.5)),
            "w2": _w((lambda *s: torch.randn(*s, dtype=torch.bfloat16) * 0.4)(F, D) * (F ** -0.5)),
        }
    _B_in = _B_setup()

    return {
        "A_x": _A_in["x"],
        "A_k_cache": _A_in["k_cache"],
        "A_v_cache": _A_in["v_cache"],
        "A_wq": _A_in["wq"],
        "A_wo": _A_in["wo"],
        "B_x": _B_in["x"],
        "B_w1": _B_in["w1"],
        "B_w2": _B_in["w2"],
    }

def reference(A_x, A_k_cache, A_v_cache, A_wq, A_wo, B_x, B_w1, B_w2):
    def _A_ref(x, k_cache, v_cache, wq, wo):
        B, Sq, D = x.shape
        Hq, Dh = 32, 128
        Hkv, Sk = k_cache.shape[1], k_cache.shape[2]
        W = min(4096, max(256, Sk // 4))
        rep = Hq // Hkv
        q = (lambda x, *d: x.permute(*d))((x @ wq).reshape(B, Sq, Hq, Dh), 0, 2, 1, 3)
        k = (lambda x, n, axis: torch.repeat_interleave(x, n, dim=axis))(k_cache[:, :, Sk - W:, :], rep, axis=1)
        v = (lambda x, n, axis: torch.repeat_interleave(x, n, dim=axis))(v_cache[:, :, Sk - W:, :], rep, axis=1)
        scores = torch.einsum("bhqd,bhkd->bhqk", q, k) * (Dh ** -0.5)
        p = _softmax(scores, axis=-1)
        o = torch.einsum("bhqk,bhkd->bhqd", p, v)
        return (lambda x, *d: x.permute(*d))(o, 0, 2, 1, 3).reshape(B, Sq, Hq * Dh) @ wo

    def _B_ref(x, w1, w2):
        h = torch.einsum("bsd,df->bsf", x, w1)
        h = _silu(h)
        out = torch.einsum("bsf,fd->bsd", h, w2)
        return out

    x = A_x
    h = x + _A_ref(_layernorm(x, axis=-1), A_k_cache, A_v_cache, A_wq, A_wo)
    h2 = h + _B_ref(_layernorm(h, axis=-1), B_w1, B_w2)
    return h2
```

```asm
; @launch grid=(256,1,1) block=(512,1,1) lds=78080
.amdgcn_target "amdgcn-amd-amdhsa--gfx950"
.text
.globl sequential_preLN__sliding_block_cached__dense_activation_silu__decode_kernel
.p2align 8
.type sequential_preLN__sliding_block_cached__dense_activation_silu__decode_kernel,@function
sequential_preLN__sliding_block_cached__dense_activation_silu__decode_kernel:
    s_cmp_ge_u32 s2, 256
    s_cbranch_scc1 L_end
    s_load_dwordx16 s[4:19], s[0:1], 0
    s_xor_b32 s2, s2, 0
    s_load_dwordx4 s[20:23], s[0:1], 64
    s_load_dwordx2 s[24:25], s[0:1], 80
    v_lshrrev_b32 v1, 6, v0
    v_and_b32 v0, 63, v0
    v_readfirstlane_b32 s26, v1
    s_and_b32 s27, s2, 7
    s_lshr_b32 s28, s2, 3
    s_mov_b32 s35, 0x3fb8aa3b
    s_mov_b32 s34, 0
    s_waitcnt lgkmcnt(0)
    s_load_dword s29, s[24:25], 0
    s_mov_b32 s36, s24
    s_mov_b32 s37, s25
    s_mov_b32 s38, 1003520
    s_mov_b32 s39, 0x00020000
    s_cmp_lt_u32 s28, 16
    s_cbranch_scc1 L_gemv
    s_mov_b32 s40, s6
    s_mov_b32 s41, s7
    s_mov_b32 s42, 33554432
    s_mov_b32 s43, 0x00020000
    s_mov_b32 s44, s8
    s_mov_b32 s45, s9
    s_mov_b32 s46, 33554432
    s_mov_b32 s47, 0x00020000
    s_sub_u32 s64, s28, 16
    s_lshr_b32 s65, s64, 3
    s_and_b32 s66, s64, 7
    s_lshl_b32 s67, s65, 3
    s_add_u32 s67, s67, s27
    s_lshl_b32 s67, s67, 13
    s_lshl_b32 s68, s66, 8
    s_add_u32 s67, s67, s68
    s_lshl_b32 s68, s26, 5
    s_add_u32 s67, s67, s68
    s_add_u32 s67, s67, 6144
    s_lshl_b32 s67, s67, 8
    s_add_u32 s68, s67, 4096
    v_and_b32 v6, 15, v0
    v_lshrrev_b32 v7, 4, v0
    v_and_b32 v1, 7, v0
    v_lshlrev_b32 v1, 8, v1
    v_lshrrev_b32 v2, 3, v0
    v_lshl_add_u32 v1, v2, 4, v1
    s_lshl_b32 s71, s27, 1
    s_add_u32 s71, s71, s65
    s_lshl_b32 s72, s71, 13
    s_add_u32 s72, s72, 593920
    v_lshlrev_b32 v21, 7, v0
    s_cmp_lg_u32 s26, 0
    s_cbranch_scc1 L_nowarmq
    buffer_load_dword v96, v21, s[36:39], s72 offen sc1
L_nowarmq:
    buffer_load_dwordx4 v[32:35], v1, s[40:43], s67 offen offset:0 nt
    buffer_load_dwordx4 v[36:39], v1, s[40:43], s67 offen offset:2048 nt
    buffer_load_dwordx4 v[40:43], v1, s[40:43], s67 offen offset:128 nt
    buffer_load_dwordx4 v[44:47], v1, s[40:43], s67 offen offset:2176 nt
    buffer_load_dwordx4 v[48:51], v1, s[40:43], s68 offen offset:0 nt
    buffer_load_dwordx4 v[52:55], v1, s[40:43], s68 offen offset:2048 nt
    buffer_load_dwordx4 v[56:59], v1, s[40:43], s68 offen offset:128 nt
    buffer_load_dwordx4 v[60:63], v1, s[40:43], s68 offen offset:2176 nt
    v_lshrrev_b32 v2, 2, v6
    v_xor_b32 v2, v2, v7
    v_and_b32 v4, 3, v6
    v_lshlrev_b32 v4, 4, v4
    v_lshl_add_u32 v4, v7, 8, v4
    v_lshl_add_u32 v2, v2, 6, v4
    s_lshl_b32 s69, s26, 13
    s_mov_b32 m0, s69
    s_nop 0
    buffer_load_dwordx4 v2, s[44:47], s67 offen offset:0 nt lds
    buffer_load_dwordx4 v2, s[44:47], s67 offen offset:1024 nt lds
    buffer_load_dwordx4 v2, s[44:47], s67 offen offset:2048 nt lds
    buffer_load_dwordx4 v2, s[44:47], s67 offen offset:3072 nt lds
    s_add_u32 s70, s69, 4096
    s_mov_b32 m0, s70
    s_nop 0
    buffer_load_dwordx4 v2, s[44:47], s68 offen offset:0 nt lds
    buffer_load_dwordx4 v2, s[44:47], s68 offen offset:1024 nt lds
    buffer_load_dwordx4 v2, s[44:47], s68 offen offset:2048 nt lds
    buffer_load_dwordx4 v2, s[44:47], s68 offen offset:3072 nt lds
    v_lshrrev_b32 v4, 2, v0
    v_and_b32 v4, 3, v4
    v_lshrrev_b32 v5, 1, v7
    v_xor_b32 v5, v5, v4
    v_lshlrev_b32 v4, 8, v4
    v_lshl_add_u32 v4, v5, 6, v4
    v_and_b32 v5, 1, v7
    v_lshl_add_u32 v4, v5, 5, v4
    v_and_b32 v5, 3, v0
    v_lshl_add_u32 v4, v5, 3, v4
    v_add_u32 v4, s69, v4
    v_xor_b32 v3, 0x80, v4
    v_and_b32 v8, 1, v5
    v_lshrrev_b32 v9, 1, v5
    v_lshlrev_b32 v5, 9, v5
    v_lshl_add_u32 v5, v8, 4, v5
    v_lshl_add_u32 v5, v9, 7, v5
    v_lshl_add_u32 v5, v7, 5, v5
    v_add_u32 v5, 65536, v5
    v_and_b32 v8, 1, v7
    v_lshrrev_b32 v9, 1, v7
    v_lshlrev_b32 v22, 9, v7
    v_lshl_add_u32 v22, v8, 4, v22
    v_lshl_add_u32 v22, v9, 7, v22
    v_lshl_add_u32 v22, v6, 4, v22
    v_add_u32 v22, 65536, v22
    s_lshl_b32 s71, s27, 1
    s_add_u32 s71, s71, s65
    s_lshl_b32 s72, s71, 13
    s_add_u32 s72, s72, 4096
    s_add_u32 s73, s72, 4096
    v_lshlrev_b32 v21, 4, v0
    v_lshlrev_b32 v22, 2, v0
    v_add_u32 v22, 65536, v22
    v_mov_b32 v20, 0xff
    s_waitcnt lgkmcnt(0)
    s_add_u32 s29, s29, 1
    s_and_b32 s30, s29, 0xff
    s_bfe_u32 s31, s29, 0x80008
    s_bfe_u32 s32, s29, 0x80010
    s_lshr_b32 s33, s29, 24
    s_waitcnt vmcnt(8)
    v_mov_b32 v8, v32
    v_mov_b32 v9, v33
    v_mov_b32 v10, v34
    v_mov_b32 v11, v35
    v_mov_b32_dpp v32, v36 row_ror:8 row_mask:0xf bank_mask:0xc
    v_mov_b32_dpp v33, v37 row_ror:8 row_mask:0xf bank_mask:0xc
    v_mov_b32_dpp v34, v38 row_ror:8 row_mask:0xf bank_mask:0xc
    v_mov_b32_dpp v35, v39 row_ror:8 row_mask:0xf bank_mask:0xc
    v_mov_b32_dpp v36, v8 row_ror:8 row_mask:0xf bank_mask:0x3
    v_mov_b32_dpp v37, v9 row_ror:8 row_mask:0xf bank_mask:0x3
    v_mov_b32_dpp v38, v10 row_ror:8 row_mask:0xf bank_mask:0x3
    v_mov_b32_dpp v39, v11 row_ror:8 row_mask:0xf bank_mask:0x3
    v_mov_b32 v8, v40
    v_mov_b32 v9, v41
    v_mov_b32 v10, v42
    v_mov_b32 v11, v43
    v_mov_b32_dpp v40, v44 row_ror:8 row_mask:0xf bank_mask:0xc
    v_mov_b32_dpp v41, v45 row_ror:8 row_mask:0xf bank_mask:0xc
    v_mov_b32_dpp v42, v46 row_ror:8 row_mask:0xf bank_mask:0xc
    v_mov_b32_dpp v43, v47 row_ror:8 row_mask:0xf bank_mask:0xc
    v_mov_b32_dpp v44, v8 row_ror:8 row_mask:0xf bank_mask:0x3
    v_mov_b32_dpp v45, v9 row_ror:8 row_mask:0xf bank_mask:0x3
    v_mov_b32_dpp v46, v10 row_ror:8 row_mask:0xf bank_mask:0x3
    v_mov_b32_dpp v47, v11 row_ror:8 row_mask:0xf bank_mask:0x3
    v_mov_b32 v8, v48
    v_mov_b32 v9, v49
    v_mov_b32 v10, v50
    v_mov_b32 v11, v51
    v_mov_b32_dpp v48, v52 row_ror:8 row_mask:0xf bank_mask:0xc
    v_mov_b32_dpp v49, v53 row_ror:8 row_mask:0xf bank_mask:0xc
    v_mov_b32_dpp v50, v54 row_ror:8 row_mask:0xf bank_mask:0xc
    v_mov_b32_dpp v51, v55 row_ror:8 row_mask:0xf bank_mask:0xc
    v_mov_b32_dpp v52, v8 row_ror:8 row_mask:0xf bank_mask:0x3
    v_mov_b32_dpp v53, v9 row_ror:8 row_mask:0xf bank_mask:0x3
    v_mov_b32_dpp v54, v10 row_ror:8 row_mask:0xf bank_mask:0x3
    v_mov_b32_dpp v55, v11 row_ror:8 row_mask:0xf bank_mask:0x3
    v_mov_b32 v8, v56
    v_mov_b32 v9, v57
    v_mov_b32 v10, v58
    v_mov_b32 v11, v59
    v_mov_b32_dpp v56, v60 row_ror:8 row_mask:0xf bank_mask:0xc
    v_mov_b32_dpp v57, v61 row_ror:8 row_mask:0xf bank_mask:0xc
    v_mov_b32_dpp v58, v62 row_ror:8 row_mask:0xf bank_mask:0xc
    v_mov_b32_dpp v59, v63 row_ror:8 row_mask:0xf bank_mask:0xc
    v_mov_b32_dpp v60, v8 row_ror:8 row_mask:0xf bank_mask:0x3
    v_mov_b32_dpp v61, v9 row_ror:8 row_mask:0xf bank_mask:0x3
    v_mov_b32_dpp v62, v10 row_ror:8 row_mask:0xf bank_mask:0x3
    v_mov_b32_dpp v63, v11 row_ror:8 row_mask:0xf bank_mask:0x3
    s_waitcnt vmcnt(4)
    ds_read_b64_tr_b16 v[64:65], v4 offset:0
    ds_read_b64_tr_b16 v[66:67], v3 offset:0
    ds_read_b64_tr_b16 v[68:69], v4 offset:1024
    ds_read_b64_tr_b16 v[70:71], v3 offset:1024
    ds_read_b64_tr_b16 v[72:73], v4 offset:2048
    ds_read_b64_tr_b16 v[74:75], v3 offset:2048
    ds_read_b64_tr_b16 v[76:77], v4 offset:3072
    ds_read_b64_tr_b16 v[78:79], v3 offset:3072
    s_waitcnt vmcnt(0)
    ds_read_b64_tr_b16 v[80:81], v4 offset:4096
    ds_read_b64_tr_b16 v[82:83], v3 offset:4096
    ds_read_b64_tr_b16 v[84:85], v4 offset:5120
    ds_read_b64_tr_b16 v[86:87], v3 offset:5120
    ds_read_b64_tr_b16 v[88:89], v4 offset:6144
    ds_read_b64_tr_b16 v[90:91], v3 offset:6144
    ds_read_b64_tr_b16 v[92:93], v4 offset:7168
    ds_read_b64_tr_b16 v[94:95], v3 offset:7168
    s_cmp_lg_u32 s26, 0
    s_cbranch_scc1 L_qwait
L_qpoll:
    s_and_b32 s75, s34, 63
    s_cmp_eq_u32 s75, 63
    s_cselect_b32 s75, 0, 589824
    s_add_u32 s4, s72, s75
    s_add_u32 s5, s73, s75
    buffer_load_dwordx4 v[96:99], v21, s[36:39], s4 offen offset:0 sc1
    buffer_load_dwordx4 v[100:103], v21, s[36:39], s4 offen offset:1024 sc1
    buffer_load_dwordx4 v[104:107], v21, s[36:39], s4 offen offset:2048 sc1
    buffer_load_dwordx4 v[108:111], v21, s[36:39], s4 offen offset:3072 sc1
    buffer_load_dwordx4 v[112:115], v21, s[36:39], s5 offen offset:0 sc1
    buffer_load_dwordx4 v[116:119], v21, s[36:39], s5 offen offset:1024 sc1
    buffer_load_dwordx4 v[120:123], v21, s[36:39], s5 offen offset:2048 sc1
    buffer_load_dwordx4 v[124:127], v21, s[36:39], s5 offen offset:3072 sc1
    s_waitcnt vmcnt(0)
    v_xor_b32 v23, s29, v97
    v_bitop3_b32 v23, v99, s29, v23 bitop3:0xbe
    v_bitop3_b32 v23, v101, s29, v23 bitop3:0xbe
    v_bitop3_b32 v23, v103, s29, v23 bitop3:0xbe
    v_bitop3_b32 v23, v105, s29, v23 bitop3:0xbe
    v_bitop3_b32 v23, v107, s29, v23 bitop3:0xbe
    v_bitop3_b32 v23, v109, s29, v23 bitop3:0xbe
    v_bitop3_b32 v23, v111, s29, v23 bitop3:0xbe
    v_bitop3_b32 v23, v113, s29, v23 bitop3:0xbe
    v_bitop3_b32 v23, v115, s29, v23 bitop3:0xbe
    v_bitop3_b32 v23, v117, s29, v23 bitop3:0xbe
    v_bitop3_b32 v23, v119, s29, v23 bitop3:0xbe
    v_bitop3_b32 v23, v121, s29, v23 bitop3:0xbe
    v_bitop3_b32 v23, v123, s29, v23 bitop3:0xbe
    v_bitop3_b32 v23, v125, s29, v23 bitop3:0xbe
    v_bitop3_b32 v23, v127, s29, v23 bitop3:0xbe
    v_cmp_ne_u32 vcc, 0, v23
    s_nop 0
    s_cmp_eq_u64 vcc, 0
    s_cbranch_scc1 L_qpoll_done
    s_mov_b64 exec, vcc
    s_sleep 1
    s_add_u32 s34, s34, 1
    s_cmp_lt_u32 s34, 131072
    s_cbranch_scc1 L_qpoll
L_qpoll_done:
    s_mov_b64 exec, -1
    v_add_f32 v96, v96, v112
    v_add_f32 v98, v98, v114
    v_add_f32 v100, v100, v116
    v_add_f32 v102, v102, v118
    v_add_f32 v104, v104, v120
    v_add_f32 v106, v106, v122
    v_add_f32 v108, v108, v124
    v_add_f32 v110, v110, v126
    v_cvt_pk_bf16_f32 v24, v96, v98
    v_cvt_pk_bf16_f32 v25, v100, v102
    v_cvt_pk_bf16_f32 v26, v104, v106
    v_cvt_pk_bf16_f32 v27, v108, v110
    ds_write_b32 v22, v24 offset:0
    ds_write_b32 v22, v25 offset:528
    ds_write_b32 v22, v26 offset:1152
    ds_write_b32 v22, v27 offset:1680
    s_waitcnt lgkmcnt(0)
L_qwait:
    s_mov_b32 s6, 0x3db504f3
    s_mov_b32 s7, 0x3db504f3
    s_mov_b32 s8, s35
    s_mov_b32 s9, s35
    v_lshlrev_b32 v25, 2, v0
    v_add_u32 v25, s69, v25
    v_lshlrev_b32 v24, 3, v0
    v_add_u32 v24, s69, v24
    s_barrier
    ds_read_b128 v[96:99], v5 offset:0
    ds_read_b128 v[100:103], v5 offset:16
    ds_read_b128 v[104:107], v5 offset:128
    ds_read_b128 v[108:111], v5 offset:144
    s_waitcnt lgkmcnt(3)
    v_mfma_f32_16x16x32_bf16 v[8:11], v[32:35], v[96:99], 0
    v_mfma_f32_16x16x32_bf16 v[12:15], v[48:51], v[96:99], 0
    s_waitcnt lgkmcnt(2)
    v_mfma_f32_16x16x32_bf16 v[8:11], v[36:39], v[100:103], v[8:11]
    v_mfma_f32_16x16x32_bf16 v[12:15], v[52:55], v[100:103], v[12:15]
    s_waitcnt lgkmcnt(1)
    v_mfma_f32_16x16x32_bf16 v[8:11], v[40:43], v[104:107], v[8:11]
    v_mfma_f32_16x16x32_bf16 v[12:15], v[56:59], v[104:107], v[12:15]
    s_waitcnt lgkmcnt(0)
    v_mfma_f32_16x16x32_bf16 v[8:11], v[44:47], v[108:111], v[8:11]
    v_mfma_f32_16x16x32_bf16 v[12:15], v[60:63], v[108:111], v[12:15]
    s_nop 6
    v_cvt_pk_bf16_f32 v16, v8, v9
    v_cvt_pk_bf16_f32 v17, v10, v11
    v_cvt_pk_bf16_f32 v18, v12, v13
    v_cvt_pk_bf16_f32 v19, v14, v15
    v_lshlrev_b32 v8, 16, v16
    v_and_b32 v9, 0xffff0000, v16
    v_lshlrev_b32 v10, 16, v17
    v_and_b32 v11, 0xffff0000, v17
    v_lshlrev_b32 v12, 16, v18
    v_and_b32 v13, 0xffff0000, v18
    v_lshlrev_b32 v14, 16, v19
    v_and_b32 v15, 0xffff0000, v19
    v_pk_mul_f32 v[8:9], v[8:9], s[6:7]
    v_pk_mul_f32 v[10:11], v[10:11], s[6:7]
    v_pk_mul_f32 v[12:13], v[12:13], s[6:7]
    v_pk_mul_f32 v[14:15], v[14:15], s[6:7]
    v_cvt_pk_bf16_f32 v16, v8, v9
    v_cvt_pk_bf16_f32 v17, v10, v11
    v_cvt_pk_bf16_f32 v18, v12, v13
    v_cvt_pk_bf16_f32 v19, v14, v15
    v_lshlrev_b32 v8, 16, v16
    v_and_b32 v9, 0xffff0000, v16
    v_lshlrev_b32 v10, 16, v17
    v_and_b32 v11, 0xffff0000, v17
    v_lshlrev_b32 v12, 16, v18
    v_and_b32 v13, 0xffff0000, v18
    v_lshlrev_b32 v14, 16, v19
    v_and_b32 v15, 0xffff0000, v19
    v_max3_f32 v22, v8, v9, v10
    v_max3_f32 v23, v11, v12, v13
    v_max3_f32 v22, v22, v14, v15
    v_max_f32 v22, v22, v23
    v_mov_b32 v23, v22
    s_nop 1
    v_permlane16_swap_b32 v22, v23
    v_max_f32 v22, v22, v23
    v_mov_b32 v23, v22
    s_nop 1
    v_permlane32_swap_b32 v22, v23
    v_max_f32 v22, v22, v23
    v_pk_add_f32 v[8:9], v[8:9], v[22:23] op_sel_hi:[1,0] neg_lo:[0,1] neg_hi:[0,1]
    v_pk_add_f32 v[10:11], v[10:11], v[22:23] op_sel_hi:[1,0] neg_lo:[0,1] neg_hi:[0,1]
    v_pk_add_f32 v[12:13], v[12:13], v[22:23] op_sel_hi:[1,0] neg_lo:[0,1] neg_hi:[0,1]
    v_pk_add_f32 v[14:15], v[14:15], v[22:23] op_sel_hi:[1,0] neg_lo:[0,1] neg_hi:[0,1]
    v_pk_mul_f32 v[8:9], v[8:9], s[8:9]
    v_pk_mul_f32 v[10:11], v[10:11], s[8:9]
    v_pk_mul_f32 v[12:13], v[12:13], s[8:9]
    v_pk_mul_f32 v[14:15], v[14:15], s[8:9]
    v_exp_f32 v8, v8
    v_exp_f32 v9, v9
    v_exp_f32 v10, v10
    v_exp_f32 v11, v11
    v_exp_f32 v12, v12
    v_exp_f32 v13, v13
    v_exp_f32 v14, v14
    v_exp_f32 v15, v15
    v_cvt_pk_bf16_f32 v16, v8, v9
    v_cvt_pk_bf16_f32 v17, v10, v11
    v_cvt_pk_bf16_f32 v18, v12, v13
    v_cvt_pk_bf16_f32 v19, v14, v15
    v_mfma_f32_4x4x4_16b_bf16 v[32:35], v[16:17], v[64:65], 0 cbsz:4 abid:0
    v_mfma_f32_4x4x4_16b_bf16 v[40:43], v[16:17], v[66:67], 0 cbsz:4 abid:0
    v_mfma_f32_4x4x4_16b_bf16 v[36:39], v[18:19], v[80:81], 0 cbsz:4 abid:0
    v_mfma_f32_4x4x4_16b_bf16 v[44:47], v[18:19], v[82:83], 0 cbsz:4 abid:0
    v_mfma_f32_4x4x4_16b_bf16 v[32:35], v[16:17], v[68:69], v[32:35] cbsz:4 abid:4
    v_mfma_f32_4x4x4_16b_bf16 v[40:43], v[16:17], v[70:71], v[40:43] cbsz:4 abid:4
    v_mfma_f32_4x4x4_16b_bf16 v[36:39], v[18:19], v[84:85], v[36:39] cbsz:4 abid:4
    v_mfma_f32_4x4x4_16b_bf16 v[44:47], v[18:19], v[86:87], v[44:47] cbsz:4 abid:4
    v_mfma_f32_4x4x4_16b_bf16 v[32:35], v[16:17], v[72:73], v[32:35] cbsz:4 abid:8
    v_mfma_f32_4x4x4_16b_bf16 v[40:43], v[16:17], v[74:75], v[40:43] cbsz:4 abid:8
    v_mfma_f32_4x4x4_16b_bf16 v[36:39], v[18:19], v[88:89], v[36:39] cbsz:4 abid:8
    v_mfma_f32_4x4x4_16b_bf16 v[44:47], v[18:19], v[90:91], v[44:47] cbsz:4 abid:8
    v_mfma_f32_4x4x4_16b_bf16 v[32:35], v[16:17], v[76:77], v[32:35] cbsz:4 abid:12
    v_mfma_f32_4x4x4_16b_bf16 v[40:43], v[16:17], v[78:79], v[40:43] cbsz:4 abid:12
    v_mfma_f32_4x4x4_16b_bf16 v[36:39], v[18:19], v[92:93], v[36:39] cbsz:4 abid:12
    v_mfma_f32_4x4x4_16b_bf16 v[44:47], v[18:19], v[94:95], v[44:47] cbsz:4 abid:12
    v_pk_add_f32 v[8:9], v[8:9], v[10:11]
    v_pk_add_f32 v[12:13], v[12:13], v[14:15]
    v_pk_add_f32 v[8:9], v[8:9], v[12:13]
    v_add_f32 v23, v8, v9
    v_mov_b32 v26, v23
    s_nop 1
    v_permlane16_swap_b32 v23, v26
    v_add_f32 v23, v23, v26
    v_mov_b32 v26, v23
    s_nop 1
    v_permlane32_swap_b32 v23, v26
    v_add_f32 v23, v23, v26
    v_pk_add_f32 v[32:33], v[32:33], v[36:37]
    v_pk_add_f32 v[34:35], v[34:35], v[38:39]
    v_pk_add_f32 v[40:41], v[40:41], v[44:45]
    v_pk_add_f32 v[42:43], v[42:43], v[46:47]
    ds_write2st64_b32 v25, v32, v40 offset0:0 offset1:1
    ds_write2st64_b32 v25, v33, v41 offset0:2 offset1:3
    ds_write2st64_b32 v25, v34, v42 offset0:4 offset1:5
    ds_write2st64_b32 v25, v35, v43 offset0:6 offset1:7
    s_mov_b64 exec, 15
    ds_write_b64 v24, v[22:23] offset:2048
    s_mov_b64 exec, -1
    s_lshl_b32 s73, s71, 3
    s_add_u32 s73, s73, s66
    s_lshl_b32 s74, s73, 7
    s_add_u32 s74, s74, 397312
    s_lshl_b32 s73, s73, 11
    s_add_u32 s73, s73, 135168
    s_add_u32 s4, s73, 589824
    s_add_u32 s5, s74, 589824
    s_lshl_b32 s6, s26, 10
    v_lshlrev_b32 v3, 4, v0
    v_add_u32 v3, s6, v3
    v_lshrrev_b32 v4, 9, v3
    v_and_b32 v5, 3, v0
    s_cmp_eq_u32 s26, 2
    s_cbranch_scc0 L_notw2
    v_mov_b32 v4, v5
L_notw2:
    v_lshlrev_b32 v4, 3, v4
    s_waitcnt lgkmcnt(0)
    s_barrier
    s_cmp_ge_u32 s26, 3
    s_cbranch_scc1 L_att_done
    ds_read_b64 v[64:65], v4 offset:2048
    ds_read_b64 v[66:67], v4 offset:10240
    ds_read_b64 v[68:69], v4 offset:18432
    ds_read_b64 v[70:71], v4 offset:26624
    ds_read_b64 v[72:73], v4 offset:34816
    ds_read_b64 v[74:75], v4 offset:43008
    ds_read_b64 v[76:77], v4 offset:51200
    ds_read_b64 v[78:79], v4 offset:59392
    ds_read_b128 v[32:35], v3 offset:0
    ds_read_b128 v[36:39], v3 offset:8192
    ds_read_b128 v[40:43], v3 offset:16384
    ds_read_b128 v[44:47], v3 offset:24576
    ds_read_b128 v[48:51], v3 offset:32768
    ds_read_b128 v[52:55], v3 offset:40960
    ds_read_b128 v[56:59], v3 offset:49152
    ds_read_b128 v[60:63], v3 offset:57344
    s_waitcnt lgkmcnt(8)
    v_max3_f32 v8, v64, v66, v68
    v_max3_f32 v9, v70, v72, v74
    v_max3_f32 v8, v8, v76, v78
    v_max_f32 v8, v8, v9
    v_sub_f32 v64, v64, v8
    v_sub_f32 v66, v66, v8
    v_sub_f32 v68, v68, v8
    v_sub_f32 v70, v70, v8
    v_sub_f32 v72, v72, v8
    v_sub_f32 v74, v74, v8
    v_sub_f32 v76, v76, v8
    v_sub_f32 v78, v78, v8
    v_mul_f32 v64, s35, v64
    v_mul_f32 v66, s35, v66
    v_mul_f32 v68, s35, v68
    v_mul_f32 v70, s35, v70
    v_mul_f32 v72, s35, v72
    v_mul_f32 v74, s35, v74
    v_mul_f32 v76, s35, v76
    v_mul_f32 v78, s35, v78
    v_exp_f32 v64, v64
    v_exp_f32 v66, v66
    v_exp_f32 v68, v68
    v_exp_f32 v70, v70
    v_exp_f32 v72, v72
    v_exp_f32 v74, v74
    v_exp_f32 v76, v76
    v_exp_f32 v78, v78
    s_cmp_eq_u32 s26, 2
    s_cbranch_scc1 L_mlpub
    s_waitcnt lgkmcnt(0)
    v_pk_mul_f32 v[12:13], v[32:33], v[64:65] op_sel_hi:[1,0]
    v_pk_mul_f32 v[14:15], v[34:35], v[64:65] op_sel_hi:[1,0]
    v_pk_fma_f32 v[12:13], v[36:37], v[66:67], v[12:13] op_sel_hi:[1,0,1]
    v_pk_fma_f32 v[14:15], v[38:39], v[66:67], v[14:15] op_sel_hi:[1,0,1]
    v_pk_fma_f32 v[12:13], v[40:41], v[68:69], v[12:13] op_sel_hi:[1,0,1]
    v_pk_fma_f32 v[14:15], v[42:43], v[68:69], v[14:15] op_sel_hi:[1,0,1]
    v_pk_fma_f32 v[12:13], v[44:45], v[70:71], v[12:13] op_sel_hi:[1,0,1]
    v_pk_fma_f32 v[14:15], v[46:47], v[70:71], v[14:15] op_sel_hi:[1,0,1]
    v_pk_fma_f32 v[12:13], v[48:49], v[72:73], v[12:13] op_sel_hi:[1,0,1]
    v_pk_fma_f32 v[14:15], v[50:51], v[72:73], v[14:15] op_sel_hi:[1,0,1]
    v_pk_fma_f32 v[12:13], v[52:53], v[74:75], v[12:13] op_sel_hi:[1,0,1]
    v_pk_fma_f32 v[14:15], v[54:55], v[74:75], v[14:15] op_sel_hi:[1,0,1]
    v_pk_fma_f32 v[12:13], v[56:57], v[76:77], v[12:13] op_sel_hi:[1,0,1]
    v_pk_fma_f32 v[14:15], v[58:59], v[76:77], v[14:15] op_sel_hi:[1,0,1]
    v_pk_fma_f32 v[12:13], v[60:61], v[78:79], v[12:13] op_sel_hi:[1,0,1]
    v_pk_fma_f32 v[14:15], v[62:63], v[78:79], v[14:15] op_sel_hi:[1,0,1]
    v_bfi_b32 v12, v20, s30, v12
    v_bfi_b32 v13, v20, s31, v13
    v_bfi_b32 v14, v20, s32, v14
    v_bfi_b32 v15, v20, s33, v15
    buffer_store_dwordx4 v[12:15], v3, s[36:39], s4 offen
    buffer_store_dwordx4 v[12:15], v3, s[36:39], s73 offen sc1
    s_branch L_att_done
L_mlpub:
    v_mul_f32 v9, v64, v65
    v_fmac_f32 v9, v66, v67
    v_fmac_f32 v9, v68, v69
    v_fmac_f32 v9, v70, v71
    v_fmac_f32 v9, v72, v73
    v_fmac_f32 v9, v74, v75
    v_fmac_f32 v9, v76, v77
    v_fmac_f32 v9, v78, v79
    v_mov_b32 v10, s29
    v_mov_b32 v11, s29
    v_lshlrev_b32 v5, 4, v0
    s_mov_b64 exec, 15
    buffer_store_dwordx4 v[8:11], v5, s[36:39], s5 offen
    buffer_store_dwordx4 v[8:11], v5, s[36:39], s74 offen sc1
    s_mov_b64 exec, -1
L_att_done:
    s_endpgm
L_gemv:
    s_mov_b32 s48, s4
    s_mov_b32 s49, s5
    s_mov_b32 s50, 2048
    s_mov_b32 s51, 0x00020000
    s_mov_b32 s40, s10
    s_mov_b32 s41, s11
    s_mov_b32 s42, 4194304
    s_mov_b32 s43, 0x00020000
    s_mov_b32 s44, s12
    s_mov_b32 s45, s13
    s_mov_b32 s46, 4194304
    s_mov_b32 s47, 0x00020000
    s_mov_b32 s52, s16
    s_mov_b32 s53, s17
    s_mov_b32 s54, 1835008
    s_mov_b32 s55, 0x00020000
    s_mov_b32 s56, s18
    s_mov_b32 s57, s19
    s_mov_b32 s58, 1835008
    s_mov_b32 s59, 0x00020000
    s_mov_b32 s60, s20
    s_mov_b32 s61, s21
    s_mov_b32 s62, 2048
    s_mov_b32 s63, 0x00020000
    s_cmp_lt_u32 s28, 8
    s_cbranch_scc1 L_noclaim
    s_cmp_lg_u32 s26, 7
    s_cbranch_scc1 L_noclaim
    s_mov_b32 s64, s22
    s_mov_b32 s65, s23
    s_mov_b32 s66, 256
    s_mov_b32 s67, 0x00020000
    v_mov_b32 v24, 1
    v_mov_b32 v25, 0
    s_mov_b64 exec, 1
    buffer_atomic_add v24, v25, s[64:67], 0 offen sc0
    s_mov_b64 exec, -1
L_noclaim:
    s_and_b32 s64, s28, 1
    s_lshr_b32 s65, s28, 1
    v_and_b32 v4, 1, v0
    v_lshrrev_b32 v5, 4, v0
    v_lshrrev_b32 v6, 2, v0
    v_bfe_u32 v7, v0, 1, 1
    v_lshlrev_b32 v1, 10, v4
    v_lshrrev_b32 v2, 1, v0
    v_lshl_add_u32 v2, v2, 5, v1
    v_lshl_add_u32 v3, v6, 3, v1
    s_lshl_b32 s66, s64, 9
    s_lshl_b32 s67, s26, 6
    s_add_u32 s66, s66, s67
    buffer_load_dwordx4 v[8:11], v2, s[48:51], 0 offen
    buffer_load_dwordx4 v[12:15], v2, s[48:51], 0 offen offset:16
    buffer_load_dword v42, v1, s[48:51], 0 offen
    buffer_load_dwordx2 v[16:17], v3, s[48:51], s66 offen
    v_and_b32 v63, 7, v0
    v_and_b32 v18, 1, v5
    v_lshlrev_b32 v18, 2, v18
    v_xor_b32 v63, v63, v18
    v_lshlrev_b32 v63, 4, v63
    v_lshrrev_b32 v40, 3, v0
    v_lshl_add_u32 v18, v40, 13, v63
    s_lshl_b32 s68, s64, 21
    s_lshl_b32 s69, s26, 18
    s_add_u32 s68, s68, s69
    s_lshl_b32 s69, s27, 10
    s_add_u32 s68, s68, s69
    s_lshl_b32 s69, s65, 7
    s_add_u32 s68, s68, s69
    s_lshl_b32 s70, s26, 13
    s_add_u32 s70, s70, 10240
    s_add_u32 s71, s70, 0
    s_mov_b32 m0, s71
    s_add_u32 s72, s68, 0
    buffer_load_dwordx4 v18, s[40:43], s72 offen nt lds
    s_add_u32 s71, s70, 1024
    s_mov_b32 m0, s71
    s_add_u32 s72, s68, 65536
    buffer_load_dwordx4 v18, s[40:43], s72 offen nt lds
    s_add_u32 s71, s70, 2048
    s_mov_b32 m0, s71
    s_add_u32 s72, s68, 131072
    buffer_load_dwordx4 v18, s[40:43], s72 offen nt lds
    s_add_u32 s71, s70, 3072
    s_mov_b32 m0, s71
    s_add_u32 s72, s68, 196608
    buffer_load_dwordx4 v18, s[40:43], s72 offen nt lds
    v_and_b32 v19, 3, v6
    v_lshrrev_b32 v20, 1, v19
    v_lshrrev_b32 v21, 1, v5
    v_xor_b32 v20, v20, v21
    v_lshlrev_b32 v62, 7, v19
    v_lshl_add_u32 v62, v20, 6, v62
    v_and_b32 v21, 1, v5
    v_lshl_add_u32 v62, v21, 5, v62
    v_and_b32 v21, 3, v0
    v_lshl_add_u32 v62, v21, 3, v62
    v_add_u32 v62, s70, v62
    v_mov_b32 v41, 0xff
    s_lshl_b32 s73, s26, 9
    v_lshlrev_b32 v43, 2, v0
    v_add_u32 v43, s73, v43
    s_waitcnt vmcnt(4)
    v_lshlrev_b32 v20, 16, v16
    v_and_b32 v21, 0xffff0000, v16
    v_lshlrev_b32 v22, 16, v17
    v_and_b32 v23, 0xffff0000, v17
    v_lshlrev_b32 v112, 16, v42
    v_lshlrev_b32 v96, 16, v8
    v_and_b32 v97, 0xffff0000, v8
    v_lshlrev_b32 v98, 16, v9
    v_and_b32 v99, 0xffff0000, v9
    v_lshlrev_b32 v100, 16, v10
    v_and_b32 v101, 0xffff0000, v10
    v_lshlrev_b32 v102, 16, v11
    v_and_b32 v103, 0xffff0000, v11
    v_lshlrev_b32 v104, 16, v12
    v_and_b32 v105, 0xffff0000, v12
    v_lshlrev_b32 v106, 16, v13
    v_and_b32 v107, 0xffff0000, v13
    v_lshlrev_b32 v108, 16, v14
    v_and_b32 v109, 0xffff0000, v14
    v_lshlrev_b32 v110, 16, v15
    v_and_b32 v111, 0xffff0000, v15
    v_pk_add_f32 v[96:97], v[96:97], v[112:113] op_sel_hi:[1,0] neg_lo:[0,1] neg_hi:[0,1]
    v_pk_add_f32 v[98:99], v[98:99], v[112:113] op_sel_hi:[1,0] neg_lo:[0,1] neg_hi:[0,1]
    v_pk_add_f32 v[100:101], v[100:101], v[112:113] op_sel_hi:[1,0] neg_lo:[0,1] neg_hi:[0,1]
    v_pk_add_f32 v[102:103], v[102:103], v[112:113] op_sel_hi:[1,0] neg_lo:[0,1] neg_hi:[0,1]
    v_pk_add_f32 v[104:105], v[104:105], v[112:113] op_sel_hi:[1,0] neg_lo:[0,1] neg_hi:[0,1]
    v_pk_add_f32 v[106:107], v[106:107], v[112:113] op_sel_hi:[1,0] neg_lo:[0,1] neg_hi:[0,1]
    v_pk_add_f32 v[108:109], v[108:109], v[112:113] op_sel_hi:[1,0] neg_lo:[0,1] neg_hi:[0,1]
    v_pk_add_f32 v[110:111], v[110:111], v[112:113] op_sel_hi:[1,0] neg_lo:[0,1] neg_hi:[0,1]
    v_pk_add_f32 v[114:115], v[96:97], v[98:99]
    v_pk_mul_f32 v[116:117], v[96:97], v[96:97]
    v_pk_fma_f32 v[116:117], v[98:99], v[98:99], v[116:117]
    v_pk_add_f32 v[114:115], v[114:115], v[100:101]
    v_pk_fma_f32 v[116:117], v[100:101], v[100:101], v[116:117]
    v_pk_add_f32 v[114:115], v[114:115], v[102:103]
    v_pk_fma_f32 v[116:117], v[102:103], v[102:103], v[116:117]
    v_pk_add_f32 v[114:115], v[114:115], v[104:105]
    v_pk_fma_f32 v[116:117], v[104:105], v[104:105], v[116:117]
    v_pk_add_f32 v[114:115], v[114:115], v[106:107]
    v_pk_fma_f32 v[116:117], v[106:107], v[106:107], v[116:117]
    v_pk_add_f32 v[114:115], v[114:115], v[108:109]
    v_pk_fma_f32 v[116:117], v[108:109], v[108:109], v[116:117]
    v_pk_add_f32 v[114:115], v[114:115], v[110:111]
    v_pk_fma_f32 v[116:117], v[110:111], v[110:111], v[116:117]
    v_add_f32 v114, v114, v115
    v_add_f32 v116, v116, v117
    s_nop 1
    v_permlane32_swap_b32 v114, v116
    v_add_f32 v114, v114, v116
    s_nop 1
    v_add_f32_dpp v114, v114, v114 row_ror:2 row_mask:0xf bank_mask:0xf
    s_nop 1
    v_add_f32_dpp v114, v114, v114 row_ror:4 row_mask:0xf bank_mask:0xf
    s_nop 1
    v_add_f32_dpp v114, v114, v114 row_ror:8 row_mask:0xf bank_mask:0xf
    v_mov_b32 v116, v114
    s_nop 1
    v_permlane16_swap_b32 v114, v116
    v_add_f32 v114, v114, v116
    v_mul_f32 v114, 0x3b000000, v114
    v_mov_b32 v116, v114
    s_nop 1
    v_permlane32_swap_b32 v114, v116
    v_fma_f32 v116, -v114, v114, v116
    v_add_f32 v114, v114, v112
    v_max_f32 v116, 0, v116
    v_cvt_pk_bf16_f32 v112, v114, v116
    v_and_b32 v116, 0xffff0000, v112
    v_lshlrev_b32 v112, 16, v112
    v_add_f32 v116, 0x3727c5ac, v116
    v_pk_add_f32 v[20:21], v[20:21], v[112:113] op_sel_hi:[1,0] neg_lo:[0,1] neg_hi:[0,1]
    v_pk_add_f32 v[22:23], v[22:23], v[112:113] op_sel_hi:[1,0] neg_lo:[0,1] neg_hi:[0,1]
    v_cvt_pk_bf16_f32 v116, v116, v116
    v_and_b32 v116, 0xffff0000, v116
    v_sqrt_f32 v116, v116
    v_cvt_pk_bf16_f32 v60, v20, v21
    v_cvt_pk_bf16_f32 v61, v22, v23
    v_cvt_pk_bf16_f32 v116, v116, v116
    v_and_b32 v116, 0xffff0000, v116
    v_rcp_f32 v116, v116
    v_lshlrev_b32 v96, 16, v60
    v_and_b32 v97, 0xffff0000, v60
    v_lshlrev_b32 v98, 16, v61
    v_and_b32 v99, 0xffff0000, v61
    v_pk_mul_f32 v[96:97], v[96:97], v[116:117] op_sel_hi:[1,0]
    v_pk_mul_f32 v[98:99], v[98:99], v[116:117] op_sel_hi:[1,0]
    v_cvt_pk_bf16_f32 v60, v96, v97
    v_cvt_pk_bf16_f32 v61, v98, v99
    s_waitcnt vmcnt(0) lgkmcnt(0)
    s_add_u32 s29, s29, 1
    s_and_b32 s30, s29, 0xff
    s_bfe_u32 s31, s29, 0x80008
    s_bfe_u32 s32, s29, 0x80010
    s_lshr_b32 s33, s29, 24
    ds_read_b64_tr_b16 v[64:65], v62 offset:0
    ds_read_b64_tr_b16 v[66:67], v62 offset:512
    ds_read_b64_tr_b16 v[68:69], v62 offset:1024
    ds_read_b64_tr_b16 v[70:71], v62 offset:1536
    ds_read_b64_tr_b16 v[72:73], v62 offset:2048
    ds_read_b64_tr_b16 v[74:75], v62 offset:2560
    ds_read_b64_tr_b16 v[76:77], v62 offset:3072
    ds_read_b64_tr_b16 v[78:79], v62 offset:3584
    s_waitcnt lgkmcnt(0)
    v_mfma_f32_4x4x4_16b_bf16 v[44:47], v[60:61], v[64:65], 0 cbsz:4 abid:0
    v_mfma_f32_4x4x4_16b_bf16 v[48:51], v[60:61], v[66:67], 0 cbsz:4 abid:1
    v_mfma_f32_4x4x4_16b_bf16 v[52:55], v[60:61], v[68:69], 0 cbsz:4 abid:2
    v_mfma_f32_4x4x4_16b_bf16 v[56:59], v[60:61], v[70:71], 0 cbsz:4 abid:3
    v_mfma_f32_4x4x4_16b_bf16 v[44:47], v[60:61], v[72:73], v[44:47] cbsz:4 abid:4
    v_mfma_f32_4x4x4_16b_bf16 v[48:51], v[60:61], v[74:75], v[48:51] cbsz:4 abid:5
    v_mfma_f32_4x4x4_16b_bf16 v[52:55], v[60:61], v[76:77], v[52:55] cbsz:4 abid:6
    v_mfma_f32_4x4x4_16b_bf16 v[56:59], v[60:61], v[78:79], v[56:59] cbsz:4 abid:7
    s_nop 2
    v_pk_add_f32 v[44:45], v[44:45], v[48:49]
    s_nop 0
    v_pk_add_f32 v[52:53], v[52:53], v[56:57]
    v_pk_add_f32 v[44:45], v[44:45], v[52:53]
    ds_write2st64_b32 v43, v44, v45 offset0:0 offset1:1
    s_cmp_lg_u32 s26, 7
    s_cbranch_scc1 L_noclaim2
    v_mov_b32 v25, 75776
    s_mov_b64 exec, 1
    ds_write_b32 v25, v24
    s_mov_b64 exec, -1
L_noclaim2:
    s_waitcnt lgkmcnt(0)
    s_barrier
    v_and_b32 v1, 31, v0
    v_lshlrev_b32 v1, 4, v1
    s_cmp_lg_u32 s26, 0
    s_cbranch_scc1 L_q_pub_done
    ds_read_b128 v[8:11], v1 offset:0
    ds_read_b128 v[12:15], v1 offset:512
    ds_read_b128 v[16:19], v1 offset:1024
    ds_read_b128 v[20:23], v1 offset:1536
    ds_read_b128 v[24:27], v1 offset:2048
    ds_read_b128 v[28:31], v1 offset:2560
    ds_read_b128 v[32:35], v1 offset:3072
    ds_read_b128 v[36:39], v1 offset:3584
    s_waitcnt lgkmcnt(0)
    v_pk_add_f32 v[8:9], v[8:9], v[24:25]
    v_pk_add_f32 v[10:11], v[10:11], v[26:27]
    v_pk_add_f32 v[12:13], v[12:13], v[28:29]
    v_pk_add_f32 v[14:15], v[14:15], v[30:31]
    v_pk_add_f32 v[16:17], v[16:17], v[32:33]
    v_pk_add_f32 v[18:19], v[18:19], v[34:35]
    v_pk_add_f32 v[20:21], v[20:21], v[36:37]
    v_pk_add_f32 v[22:23], v[22:23], v[38:39]
    v_pk_add_f32 v[8:9], v[8:9], v[16:17]
    v_pk_add_f32 v[10:11], v[10:11], v[18:19]
    v_pk_add_f32 v[12:13], v[12:13], v[20:21]
    v_pk_add_f32 v[14:15], v[14:15], v[22:23]
    v_pk_add_f32 v[8:9], v[8:9], v[12:13]
    v_pk_add_f32 v[10:11], v[10:11], v[14:15]
    s_lshl_b32 s71, s27, 14
    s_lshl_b32 s72, s64, 12
    s_add_u32 s71, s71, s72
    s_lshl_b32 s72, s65, 9
    s_add_u32 s71, s71, s72
    s_add_u32 s71, s71, 4096
    v_and_b32 v20, 15, v0
    v_lshlrev_b32 v20, 5, v20
    v_lshl_add_u32 v20, v5, 13, v20
    v_mov_b32 v12, v8
    v_mov_b32 v13, s29
    v_mov_b32 v14, v9
    v_mov_b32 v15, s29
    v_mov_b32 v16, v10
    v_mov_b32 v17, s29
    v_mov_b32 v18, v11
    v_mov_b32 v19, s29
    s_mov_b32 exec_hi, 0
    s_add_u32 s72, s71, 589824
    buffer_store_dwordx4 v[12:15], v20, s[36:39], s72 offen
    buffer_store_dwordx4 v[16:19], v20, s[36:39], s72 offen offset:16
    buffer_store_dwordx4 v[12:15], v20, s[36:39], s71 offen sc1
    buffer_store_dwordx4 v[16:19], v20, s[36:39], s71 offen offset:16 sc1
    s_mov_b64 exec, -1
L_q_pub_done:
    s_cmp_ge_u32 s28, 8
    s_cbranch_scc1 L_ffn_role
    v_lshl_add_u32 v18, v40, 10, v63
    s_lshl_b32 s68, s27, 19
    s_lshl_b32 s69, s26, 16
    s_add_u32 s68, s68, s69
    s_lshl_b32 s69, s28, 7
    s_add_u32 s68, s68, s69
    s_add_u32 s71, s70, 0
    s_mov_b32 m0, s71
    s_add_u32 s72, s68, 0
    buffer_load_dwordx4 v18, s[44:47], s72 offen nt lds
    s_add_u32 s71, s70, 1024
    s_mov_b32 m0, s71
    s_add_u32 s72, s68, 8192
    buffer_load_dwordx4 v18, s[44:47], s72 offen nt lds
    s_add_u32 s71, s70, 2048
    s_mov_b32 m0, s71
    s_add_u32 s72, s68, 16384
    buffer_load_dwordx4 v18, s[44:47], s72 offen nt lds
    s_add_u32 s71, s70, 3072
    s_mov_b32 m0, s71
    s_add_u32 s72, s68, 24576
    buffer_load_dwordx4 v18, s[44:47], s72 offen nt lds
    s_add_u32 s71, s70, 4096
    s_mov_b32 m0, s71
    s_add_u32 s72, s68, 32768
    buffer_load_dwordx4 v18, s[44:47], s72 offen nt lds
    s_add_u32 s71, s70, 5120
    s_mov_b32 m0, s71
    s_add_u32 s72, s68, 40960
    buffer_load_dwordx4 v18, s[44:47], s72 offen nt lds
    s_add_u32 s71, s70, 6144
    s_mov_b32 m0, s71
    s_add_u32 s72, s68, 49152
    buffer_load_dwordx4 v18, s[44:47], s72 offen nt lds
    s_add_u32 s71, s70, 7168
    s_mov_b32 m0, s71
    s_add_u32 s72, s68, 57344
    buffer_load_dwordx4 v18, s[44:47], s72 offen nt lds
    v_and_b32 v2, 15, v0
    v_lshlrev_b32 v2, 4, v2
    v_lshl_add_u32 v2, v5, 13, v2
    s_lshl_b32 s4, s27, 15
    s_lshl_b32 s71, s26, 8
    s_add_u32 s4, s4, s71
    s_add_u32 s4, s4, 135168
    s_add_u32 s5, s4, 4096
    v_lshlrev_b32 v3, 9, v5
    v_lshlrev_b32 v42, 7, v4
    v_lshl_add_u32 v42, v6, 2, v42
    s_lshl_b32 s6, s27, 11
    s_lshr_b32 s73, s26, 1
    s_lshl_b32 s73, s73, 4
    s_add_u32 s6, s6, s73
    s_add_u32 s6, s6, 397312
    s_add_u32 s8, s4, 589824
    s_add_u32 s9, s5, 589824
    buffer_load_dwordx4 v[8:11], v2, s[36:39], s8 offen offset:0 sc1
    buffer_load_dwordx4 v[12:15], v2, s[36:39], s8 offen offset:2048 sc1
    buffer_load_dwordx4 v[16:19], v2, s[36:39], s9 offen offset:0 sc1
    buffer_load_dwordx4 v[20:23], v2, s[36:39], s9 offen offset:2048 sc1
    s_add_u32 s7, s6, 589824
    buffer_load_dwordx4 v[28:31], v3, s[36:39], s7 offen offset:128 sc1
    buffer_load_dwordx4 v[32:35], v3, s[36:39], s7 offen offset:256 sc1
    buffer_load_dwordx4 v[36:39], v3, s[36:39], s7 offen offset:384 sc1
    s_waitcnt vmcnt(7)
    ds_read_b64_tr_b16 v[64:65], v62 offset:0
    ds_read_b64_tr_b16 v[66:67], v62 offset:512
    ds_read_b64_tr_b16 v[68:69], v62 offset:1024
    ds_read_b64_tr_b16 v[70:71], v62 offset:1536
    ds_read_b64_tr_b16 v[72:73], v62 offset:2048
    ds_read_b64_tr_b16 v[74:75], v62 offset:2560
    ds_read_b64_tr_b16 v[76:77], v62 offset:3072
    ds_read_b64_tr_b16 v[78:79], v62 offset:3584
    ds_read_b64_tr_b16 v[80:81], v62 offset:4096
    ds_read_b64_tr_b16 v[82:83], v62 offset:4608
    ds_read_b64_tr_b16 v[84:85], v62 offset:5120
    ds_read_b64_tr_b16 v[86:87], v62 offset:5632
    ds_read_b64_tr_b16 v[88:89], v62 offset:6144
    ds_read_b64_tr_b16 v[90:91], v62 offset:6656
    ds_read_b64_tr_b16 v[92:93], v62 offset:7168
    ds_read_b64_tr_b16 v[94:95], v62 offset:7680
    s_waitcnt lgkmcnt(0)
L_p_pre:
    s_and_b32 s75, s34, 63
    s_cmp_eq_u32 s75, 63
    s_cselect_b32 s75, 0, 589824
    s_add_u32 s7, s6, s75
    buffer_load_dwordx4 v[24:27], v3, s[36:39], s7 offen sc1
    s_waitcnt vmcnt(0)
    v_cmp_eq_u32 vcc, s29, v26
    s_nop 0
    s_cmp_lg_u64 vcc, 0
    s_cbranch_scc1 L_p_go
    s_sleep 2
    s_add_u32 s34, s34, 1
    s_cmp_lt_u32 s34, 131072
    s_cbranch_scc1 L_p_pre
L_p_go:
    s_mov_b32 s34, 0
L_p_poll:
    s_and_b32 s75, s34, 63
    s_cmp_eq_u32 s75, 63
    s_cselect_b32 s75, 0, 589824
    s_add_u32 s7, s6, s75
    s_add_u32 s8, s4, s75
    s_add_u32 s9, s5, s75
    buffer_load_dwordx4 v[24:27], v3, s[36:39], s7 offen offset:0 sc1
    buffer_load_dwordx4 v[28:31], v3, s[36:39], s7 offen offset:128 sc1
    buffer_load_dwordx4 v[32:35], v3, s[36:39], s7 offen offset:256 sc1
    buffer_load_dwordx4 v[36:39], v3, s[36:39], s7 offen offset:384 sc1
    buffer_load_dwordx4 v[8:11], v2, s[36:39], s8 offen offset:0 sc1
    buffer_load_dwordx4 v[12:15], v2, s[36:39], s8 offen offset:2048 sc1
    buffer_load_dwordx4 v[16:19], v2, s[36:39], s9 offen offset:0 sc1
    buffer_load_dwordx4 v[20:23], v2, s[36:39], s9 offen offset:2048 sc1
    s_waitcnt vmcnt(0)
    v_xor_b32 v8, s30, v8
    v_xor_b32 v9, s31, v9
    v_xor_b32 v10, s32, v10
    v_xor_b32 v11, s33, v11
    v_xor_b32 v12, s30, v12
    v_xor_b32 v13, s31, v13
    v_xor_b32 v14, s32, v14
    v_xor_b32 v15, s33, v15
    v_xor_b32 v16, s30, v16
    v_xor_b32 v17, s31, v17
    v_xor_b32 v18, s32, v18
    v_xor_b32 v19, s33, v19
    v_xor_b32 v20, s30, v20
    v_xor_b32 v21, s31, v21
    v_xor_b32 v22, s32, v22
    v_xor_b32 v23, s33, v23
    v_or3_b32 v40, v8, v9, v10
    v_or3_b32 v40, v40, v11, v12
    v_or3_b32 v40, v40, v13, v14
    v_or3_b32 v40, v40, v15, v16
    v_or3_b32 v40, v40, v17, v18
    v_or3_b32 v40, v40, v19, v20
    v_or3_b32 v40, v40, v21, v22
    v_or_b32 v40, v40, v23
    v_and_b32 v40, 0xff, v40
    v_bitop3_b32 v40, v26, s29, v40 bitop3:0xbe
    v_bitop3_b32 v40, v30, s29, v40 bitop3:0xbe
    v_bitop3_b32 v40, v34, s29, v40 bitop3:0xbe
    v_bitop3_b32 v40, v38, s29, v40 bitop3:0xbe
    v_cmp_ne_u32 vcc, 0, v40
    s_nop 0
    s_cmp_eq_u64 vcc, 0
    s_cbranch_scc1 L_p_poll_done
    s_mov_b64 exec, vcc
    s_add_u32 s34, s34, 1
    s_cmp_lt_u32 s34, 131072
    s_cbranch_scc1 L_p_poll
L_p_poll_done:
    s_mov_b64 exec, -1
    v_max3_f32 v40, v24, v28, v32
    v_max_f32 v40, v40, v36
    v_mov_b32 v48, v40
    s_nop 1
    v_permlane16_swap_b32 v40, v48
    v_max_f32 v40, v40, v48
    v_sub_f32 v24, v24, v40
    v_sub_f32 v28, v28, v40
    v_sub_f32 v32, v32, v40
    v_sub_f32 v36, v36, v40
    v_mul_f32 v24, s35, v24
    v_mul_f32 v28, s35, v28
    v_mul_f32 v32, s35, v32
    v_mul_f32 v36, s35, v36
    v_exp_f32 v24, v24
    v_exp_f32 v28, v28
    v_exp_f32 v32, v32
    v_exp_f32 v36, v36
    v_mul_f32 v40, v24, v25
    v_pk_mul_f32 v[44:45], v[8:9], v[24:25] op_sel_hi:[1,0]
    v_pk_mul_f32 v[46:47], v[10:11], v[24:25] op_sel_hi:[1,0]
    v_fmac_f32 v40, v28, v29
    v_pk_fma_f32 v[44:45], v[12:13], v[28:29], v[44:45] op_sel_hi:[1,0,1]
    v_pk_fma_f32 v[46:47], v[14:15], v[28:29], v[46:47] op_sel_hi:[1,0,1]
    v_fmac_f32 v40, v32, v33
    v_pk_fma_f32 v[44:45], v[16:17], v[32:33], v[44:45] op_sel_hi:[1,0,1]
    v_pk_fma_f32 v[46:47], v[18:19], v[32:33], v[46:47] op_sel_hi:[1,0,1]
    v_fmac_f32 v40, v36, v37
    v_pk_fma_f32 v[44:45], v[20:21], v[36:37], v[44:45] op_sel_hi:[1,0,1]
    v_pk_fma_f32 v[46:47], v[22:23], v[36:37], v[46:47] op_sel_hi:[1,0,1]
    v_mov_b32 v48, v40
    s_nop 1
    v_permlane16_swap_b32 v40, v48
    v_add_f32 v40, v40, v48
    v_rcp_f32 v50, v40
    v_permlane16_swap_b32 v44, v46
    v_permlane16_swap_b32 v45, v47
    v_pk_add_f32 v[44:45], v[44:45], v[46:47]
    v_pk_mul_f32 v[44:45], v[44:45], v[50:51] op_sel_hi:[1,0]
    v_cvt_pk_bf16_f32 v44, v44, v45
    ds_bpermute_b32 v60, v42, v44
    ds_bpermute_b32 v61, v42, v44 offset:64
    s_waitcnt lgkmcnt(0)
    v_mfma_f32_4x4x4_16b_bf16 v[44:47], v[60:61], v[64:65], 0 cbsz:4 abid:0
    v_mfma_f32_4x4x4_16b_bf16 v[48:51], v[60:61], v[66:67], 0 cbsz:4 abid:1
    v_mfma_f32_4x4x4_16b_bf16 v[52:55], v[60:61], v[68:69], 0 cbsz:4 abid:2
    v_mfma_f32_4x4x4_16b_bf16 v[56:59], v[60:61], v[70:71], 0 cbsz:4 abid:3
    v_mfma_f32_4x4x4_16b_bf16 v[44:47], v[60:61], v[72:73], v[44:47] cbsz:4 abid:4
    v_mfma_f32_4x4x4_16b_bf16 v[48:51], v[60:61], v[74:75], v[48:51] cbsz:4 abid:5
    v_mfma_f32_4x4x4_16b_bf16 v[52:55], v[60:61], v[76:77], v[52:55] cbsz:4 abid:6
    v_mfma_f32_4x4x4_16b_bf16 v[56:59], v[60:61], v[78:79], v[56:59] cbsz:4 abid:7
    v_mfma_f32_4x4x4_16b_bf16 v[44:47], v[60:61], v[80:81], v[44:47] cbsz:4 abid:8
    v_mfma_f32_4x4x4_16b_bf16 v[48:51], v[60:61], v[82:83], v[48:51] cbsz:4 abid:9
    v_mfma_f32_4x4x4_16b_bf16 v[52:55], v[60:61], v[84:85], v[52:55] cbsz:4 abid:10
    v_mfma_f32_4x4x4_16b_bf16 v[56:59], v[60:61], v[86:87], v[56:59] cbsz:4 abid:11
    v_mfma_f32_4x4x4_16b_bf16 v[44:47], v[60:61], v[88:89], v[44:47] cbsz:4 abid:12
    v_mfma_f32_4x4x4_16b_bf16 v[48:51], v[60:61], v[90:91], v[48:51] cbsz:4 abid:13
    v_mfma_f32_4x4x4_16b_bf16 v[52:55], v[60:61], v[92:93], v[52:55] cbsz:4 abid:14
    v_mfma_f32_4x4x4_16b_bf16 v[56:59], v[60:61], v[94:95], v[56:59] cbsz:4 abid:15
    s_nop 2
    v_pk_add_f32 v[44:45], v[44:45], v[48:49]
    s_nop 0
    v_pk_add_f32 v[52:53], v[52:53], v[56:57]
    v_pk_add_f32 v[44:45], v[44:45], v[52:53]
    ds_write2st64_b32 v43, v44, v45 offset0:16 offset1:17
    s_waitcnt vmcnt(0) lgkmcnt(0)
    s_barrier
    s_cmp_lg_u32 s26, 0
    s_cbranch_scc1 L_o_done
    ds_read_b128 v[8:11], v1 offset:4096
    ds_read_b128 v[12:15], v1 offset:4608
    ds_read_b128 v[16:19], v1 offset:5120
    ds_read_b128 v[20:23], v1 offset:5632
    ds_read_b128 v[24:27], v1 offset:6144
    ds_read_b128 v[28:31], v1 offset:6656
    ds_read_b128 v[32:35], v1 offset:7168
    ds_read_b128 v[36:39], v1 offset:7680
    s_waitcnt lgkmcnt(0)
    v_pk_add_f32 v[8:9], v[8:9], v[24:25]
    v_pk_add_f32 v[10:11], v[10:11], v[26:27]
    v_pk_add_f32 v[12:13], v[12:13], v[28:29]
    v_pk_add_f32 v[14:15], v[14:15], v[30:31]
    v_pk_add_f32 v[16:17], v[16:17], v[32:33]
    v_pk_add_f32 v[18:19], v[18:19], v[34:35]
    v_pk_add_f32 v[20:21], v[20:21], v[36:37]
    v_pk_add_f32 v[22:23], v[22:23], v[38:39]
    v_pk_add_f32 v[8:9], v[8:9], v[16:17]
    v_pk_add_f32 v[10:11], v[10:11], v[18:19]
    v_pk_add_f32 v[12:13], v[12:13], v[20:21]
    v_pk_add_f32 v[14:15], v[14:15], v[22:23]
    v_pk_add_f32 v[8:9], v[8:9], v[12:13]
    v_pk_add_f32 v[10:11], v[10:11], v[14:15]
    s_lshl_b32 s71, s27, 12
    s_lshl_b32 s72, s28, 8
    s_add_u32 s71, s71, s72
    s_add_u32 s71, s71, 413696
    v_and_b32 v12, 15, v0
    v_lshlrev_b32 v12, 4, v12
    v_lshl_add_u32 v12, v5, 11, v12
    v_bfi_b32 v8, v41, s30, v8
    v_bfi_b32 v9, v41, s31, v9
    v_bfi_b32 v10, v41, s32, v10
    v_bfi_b32 v11, v41, s33, v11
    s_mov_b32 exec_hi, 0
    buffer_store_dwordx4 v[8:11], v12, s[36:39], s71 offen sc1
    s_mov_b64 exec, -1
L_o_done:
    s_endpgm
L_ffn_role:
    v_mov_b32 v25, 75776
    ds_read_b32 v24, v25
    s_waitcnt lgkmcnt(0)
    v_readfirstlane_b32 s64, v24
    s_nop 0
    s_and_b32 s64, s64, 63
    s_cmp_ge_u32 s64, 28
    s_cbranch_scc1 L_g_done
    s_movk_i32 s65, 3584
    v_mul_lo_u32 v18, v40, s65
    v_add_u32 v18, v18, v63
    s_mul_i32 s68, s26, 229376
    s_lshl_b32 s69, s64, 7
    s_add_u32 s68, s68, s69
    s_add_u32 s71, s70, 0
    s_mov_b32 m0, s71
    s_add_u32 s72, s68, 0
    buffer_load_dwordx4 v18, s[52:55], s72 offen nt lds
    s_add_u32 s71, s70, 1024
    s_mov_b32 m0, s71
    s_add_u32 s72, s68, 28672
    buffer_load_dwordx4 v18, s[52:55], s72 offen nt lds
    s_add_u32 s71, s70, 2048
    s_mov_b32 m0, s71
    s_add_u32 s72, s68, 57344
    buffer_load_dwordx4 v18, s[52:55], s72 offen nt lds
    s_add_u32 s71, s70, 3072
    s_mov_b32 m0, s71
    s_add_u32 s72, s68, 86016
    buffer_load_dwordx4 v18, s[52:55], s72 offen nt lds
    s_add_u32 s71, s70, 4096
    s_mov_b32 m0, s71
    s_add_u32 s72, s68, 114688
    buffer_load_dwordx4 v18, s[52:55], s72 offen nt lds
    s_add_u32 s71, s70, 5120
    s_mov_b32 m0, s71
    s_add_u32 s72, s68, 143360
    buffer_load_dwordx4 v18, s[52:55], s72 offen nt lds
    s_add_u32 s71, s70, 6144
    s_mov_b32 m0, s71
    s_add_u32 s72, s68, 172032
    buffer_load_dwordx4 v18, s[52:55], s72 offen nt lds
    s_add_u32 s71, s70, 7168
    s_mov_b32 m0, s71
    s_add_u32 s72, s68, 200704
    buffer_load_dwordx4 v18, s[52:55], s72 offen nt lds
    v_lshl_add_u32 v19, v40, 10, v63
    s_lshl_b32 s68, s64, 16
    s_lshl_b32 s69, s26, 7
    s_add_u32 s68, s68, s69
    s_add_u32 s72, s68, 0
    buffer_load_dwordx4 v[96:99], v19, s[56:59], s72 offen nt
    s_add_u32 s72, s68, 8192
    buffer_load_dwordx4 v[100:103], v19, s[56:59], s72 offen nt
    s_add_u32 s72, s68, 16384
    buffer_load_dwordx4 v[104:107], v19, s[56:59], s72 offen nt
    s_add_u32 s72, s68, 24576
    buffer_load_dwordx4 v[108:111], v19, s[56:59], s72 offen nt
    s_add_u32 s72, s68, 32768
    buffer_load_dwordx4 v[112:115], v19, s[56:59], s72 offen nt
    s_add_u32 s72, s68, 40960
    buffer_load_dwordx4 v[116:119], v19, s[56:59], s72 offen nt
    s_add_u32 s72, s68, 49152
    buffer_load_dwordx4 v[120:123], v19, s[56:59], s72 offen nt
    s_add_u32 s72, s68, 57344
    buffer_load_dwordx4 v[124:127], v19, s[56:59], s72 offen nt
    v_add_u32 v3, s69, v3
    v_and_b32 v20, 15, v0
    v_and_b32 v21, 1, v5
    v_lshrrev_b32 v22, 1, v5
    v_lshlrev_b32 v39, 10, v22
    v_lshl_add_u32 v39, v20, 3, v39
    v_lshl_add_u32 v39, v21, 2, v39
    v_add_u32 v39, s69, v39
    buffer_load_dword v38, v39, s[48:51], 0 offen
    v_lshlrev_b32 v36, 14, v21
    v_lshl_add_u32 v36, v22, 11, v36
    v_lshl_add_u32 v36, v20, 4, v36
    s_lshl_b32 s8, s26, 8
    s_add_u32 s8, s8, 413696
    s_add_u32 s9, s8, 4096
    s_add_u32 s10, s8, 8192
    s_add_u32 s11, s8, 12288
    v_lshlrev_b32 v37, 4, v0
    v_add_u32 v37, s70, v37
    buffer_load_dwordx4 v[8:11], v36, s[36:39], s8 offen sc1
    buffer_load_dwordx4 v[12:15], v36, s[36:39], s9 offen sc1
    buffer_load_dwordx4 v[16:19], v36, s[36:39], s10 offen sc1
    buffer_load_dwordx4 v[20:23], v36, s[36:39], s11 offen sc1
    s_and_b32 s71, s64, 15
    s_lshl_b32 s71, s71, 3
    s_add_u32 s71, s71, s26
    s_lshl_b32 s72, s71, 5
    s_add_u32 s72, s72, 446464
    v_lshrrev_b32 v28, 1, v0
    v_min_u32 v28, 27, v28
    v_lshlrev_b32 v28, 12, v28
    v_lshl_add_u32 v28, v4, 4, v28
    buffer_load_dwordx4 v[24:27], v28, s[36:39], s72 offen sc1
    s_waitcnt vmcnt(14)
    ds_read_b64_tr_b16 v[64:65], v62 offset:0
    ds_read_b64_tr_b16 v[66:67], v62 offset:512
    ds_read_b64_tr_b16 v[68:69], v62 offset:1024
    ds_read_b64_tr_b16 v[70:71], v62 offset:1536
    ds_read_b64_tr_b16 v[72:73], v62 offset:2048
    ds_read_b64_tr_b16 v[74:75], v62 offset:2560
    ds_read_b64_tr_b16 v[76:77], v62 offset:3072
    ds_read_b64_tr_b16 v[78:79], v62 offset:3584
    ds_read_b64_tr_b16 v[80:81], v62 offset:4096
    ds_read_b64_tr_b16 v[82:83], v62 offset:4608
    ds_read_b64_tr_b16 v[84:85], v62 offset:5120
    ds_read_b64_tr_b16 v[86:87], v62 offset:5632
    ds_read_b64_tr_b16 v[88:89], v62 offset:6144
    ds_read_b64_tr_b16 v[90:91], v62 offset:6656
    ds_read_b64_tr_b16 v[92:93], v62 offset:7168
    ds_read_b64_tr_b16 v[94:95], v62 offset:7680
    s_waitcnt vmcnt(5) lgkmcnt(0)
    ds_write_b128 v37, v[96:99] offset:0
    ds_write_b128 v37, v[100:103] offset:1024
    ds_write_b128 v37, v[104:107] offset:2048
    ds_write_b128 v37, v[108:111] offset:3072
    ds_write_b128 v37, v[112:115] offset:4096
    ds_write_b128 v37, v[116:119] offset:5120
    ds_write_b128 v37, v[120:123] offset:6144
    ds_write_b128 v37, v[124:127] offset:7168
    s_waitcnt lgkmcnt(0)
    ds_read_b64_tr_b16 v[96:97], v62 offset:0
    ds_read_b64_tr_b16 v[98:99], v62 offset:512
    ds_read_b64_tr_b16 v[100:101], v62 offset:1024
    ds_read_b64_tr_b16 v[102:103], v62 offset:1536
    ds_read_b64_tr_b16 v[104:105], v62 offset:2048
    ds_read_b64_tr_b16 v[106:107], v62 offset:2560
    ds_read_b64_tr_b16 v[108:109], v62 offset:3072
    ds_read_b64_tr_b16 v[110:111], v62 offset:3584
    ds_read_b64_tr_b16 v[112:113], v62 offset:4096
    ds_read_b64_tr_b16 v[114:115], v62 offset:4608
    ds_read_b64_tr_b16 v[116:117], v62 offset:5120
    ds_read_b64_tr_b16 v[118:119], v62 offset:5632
    ds_read_b64_tr_b16 v[120:121], v62 offset:6144
    ds_read_b64_tr_b16 v[122:123], v62 offset:6656
    ds_read_b64_tr_b16 v[124:125], v62 offset:7168
    ds_read_b64_tr_b16 v[126:127], v62 offset:7680
    v_mov_b32 v60, 0x3f803f80
    v_mov_b32 v61, 0x3f803f80
    v_mov_b32 v3, v38
    v_mov_b32 v63, v39
    v_lshrrev_b32 v1, 1, v43
    v_and_b32 v1, 0xffffff00, v1
    v_lshl_add_u32 v1, v0, 2, v1
    v_add_u32 v1, 76032, v1
    v_mfma_f32_4x4x4_16b_bf16 v[44:47], v[60:61], v[64:65], 0 cbsz:4 abid:0
    v_mfma_f32_4x4x4_16b_bf16 v[48:51], v[60:61], v[66:67], 0 cbsz:4 abid:1
    v_mfma_f32_4x4x4_16b_bf16 v[52:55], v[60:61], v[68:69], 0 cbsz:4 abid:2
    v_mfma_f32_4x4x4_16b_bf16 v[44:47], v[60:61], v[70:71], v[44:47] cbsz:4 abid:3
    v_mfma_f32_4x4x4_16b_bf16 v[48:51], v[60:61], v[72:73], v[48:51] cbsz:4 abid:4
    v_mfma_f32_4x4x4_16b_bf16 v[52:55], v[60:61], v[74:75], v[52:55] cbsz:4 abid:5
    v_mfma_f32_4x4x4_16b_bf16 v[44:47], v[60:61], v[76:77], v[44:47] cbsz:4 abid:6
    v_mfma_f32_4x4x4_16b_bf16 v[48:51], v[60:61], v[78:79], v[48:51] cbsz:4 abid:7
    v_mfma_f32_4x4x4_16b_bf16 v[52:55], v[60:61], v[80:81], v[52:55] cbsz:4 abid:8
    v_mfma_f32_4x4x4_16b_bf16 v[44:47], v[60:61], v[82:83], v[44:47] cbsz:4 abid:9
    v_mfma_f32_4x4x4_16b_bf16 v[48:51], v[60:61], v[84:85], v[48:51] cbsz:4 abid:10
    v_mfma_f32_4x4x4_16b_bf16 v[52:55], v[60:61], v[86:87], v[52:55] cbsz:4 abid:11
    v_mfma_f32_4x4x4_16b_bf16 v[44:47], v[60:61], v[88:89], v[44:47] cbsz:4 abid:12
    v_mfma_f32_4x4x4_16b_bf16 v[48:51], v[60:61], v[90:91], v[48:51] cbsz:4 abid:13
    v_mfma_f32_4x4x4_16b_bf16 v[52:55], v[60:61], v[92:93], v[52:55] cbsz:4 abid:14
    v_mfma_f32_4x4x4_16b_bf16 v[44:47], v[60:61], v[94:95], v[44:47] cbsz:4 abid:15
    s_nop 3
    v_pk_add_f32 v[48:49], v[48:49], v[52:53]
    v_pk_add_f32 v[44:45], v[44:45], v[48:49]
    ds_write_b32 v1, v44
    v_mov_b32 v62, v36
    v_lshlrev_b32 v40, 8, v4
    v_lshl_add_u32 v40, v6, 4, v40
    v_lshl_add_u32 v40, v7, 11, v40
    v_lshlrev_b32 v42, 7, v4
    v_lshl_add_u32 v42, v6, 2, v42
    v_lshlrev_b32 v2, 4, v6
    v_lshl_add_u32 v2, v7, 10, v2
    v_add_u32 v2, 76032, v2
    s_waitcnt vmcnt(0) lgkmcnt(0)
    s_barrier
    ds_read_b128 v[8:11], v2 offset:0
    ds_read_b128 v[12:15], v2 offset:256
    ds_read_b128 v[16:19], v2 offset:512
    ds_read_b128 v[20:23], v2 offset:768
    v_lshrrev_b32 v1, 1, v5
    v_lshlrev_b32 v1, 6, v1
    v_and_b32 v2, 1, v5
    v_lshl_add_u32 v1, v2, 2, v1
    s_lshl_b32 s71, s26, 3
    v_add_u32 v1, s71, v1
    v_lshlrev_b32 v2, 6, v4
    v_lshl_add_u32 v2, v7, 5, v2
    s_waitcnt lgkmcnt(0)
    v_pk_add_f32 v[8:9], v[8:9], v[16:17]
    v_pk_add_f32 v[10:11], v[10:11], v[18:19]
    v_pk_add_f32 v[12:13], v[12:13], v[20:21]
    v_pk_add_f32 v[14:15], v[14:15], v[22:23]
    v_pk_add_f32 v[8:9], v[8:9], v[12:13]
    v_pk_add_f32 v[10:11], v[10:11], v[14:15]
    s_nop 0
    v_add_f32_dpp v56, v8, v8 quad_perm:[2,3,0,1] row_mask:0xf bank_mask:0xf
    v_add_f32_dpp v57, v9, v9 quad_perm:[2,3,0,1] row_mask:0xf bank_mask:0xf
    v_add_f32_dpp v58, v10, v10 quad_perm:[2,3,0,1] row_mask:0xf bank_mask:0xf
    v_add_f32_dpp v59, v11, v11 quad_perm:[2,3,0,1] row_mask:0xf bank_mask:0xf
L_a_pre:
    buffer_load_dwordx4 v[8:11], v62, s[36:39], s8 offen sc1
    s_waitcnt vmcnt(0)
    v_xor_b32 v8, s30, v8
    v_xor_b32 v9, s31, v9
    v_xor_b32 v10, s32, v10
    v_xor_b32 v11, s33, v11
    v_or3_b32 v44, v8, v9, v10
    v_or_b32 v44, v44, v11
    v_and_b32 v44, 0xff, v44
    v_cmp_eq_u32 vcc, 0, v44
    s_nop 0
    s_cmp_lg_u64 vcc, 0
    s_cbranch_scc1 L_a_go
    s_sleep 2
    s_add_u32 s34, s34, 1
    s_cmp_lt_u32 s34, 131072
    s_cbranch_scc1 L_a_pre
L_a_go:
    s_mov_b32 s34, 0
L_a_poll:
    buffer_load_dwordx4 v[8:11], v62, s[36:39], s8 offen sc1
    buffer_load_dwordx4 v[12:15], v62, s[36:39], s9 offen sc1
    buffer_load_dwordx4 v[16:19], v62, s[36:39], s10 offen sc1
    buffer_load_dwordx4 v[20:23], v62, s[36:39], s11 offen sc1
    s_waitcnt vmcnt(0)
    v_xor_b32 v8, s30, v8
    v_xor_b32 v9, s31, v9
    v_xor_b32 v10, s32, v10
    v_xor_b32 v11, s33, v11
    v_xor_b32 v12, s30, v12
    v_xor_b32 v13, s31, v13
    v_xor_b32 v14, s32, v14
    v_xor_b32 v15, s33, v15
    v_xor_b32 v16, s30, v16
    v_xor_b32 v17, s31, v17
    v_xor_b32 v18, s32, v18
    v_xor_b32 v19, s33, v19
    v_xor_b32 v20, s30, v20
    v_xor_b32 v21, s31, v21
    v_xor_b32 v22, s32, v22
    v_xor_b32 v23, s33, v23
    v_or3_b32 v44, v8, v9, v10
    v_or3_b32 v44, v44, v11, v12
    v_or3_b32 v44, v44, v13, v14
    v_or3_b32 v44, v44, v15, v16
    v_or3_b32 v44, v44, v17, v18
    v_or3_b32 v44, v44, v19, v20
    v_or3_b32 v44, v44, v21, v22
    v_or_b32 v44, v44, v23
    v_and_b32 v44, 0xff, v44
    v_cmp_ne_u32 vcc, 0, v44
    s_nop 0
    s_cmp_eq_u64 vcc, 0
    s_cbranch_scc1 L_a_poll_done
    s_mov_b64 exec, vcc
    s_add_u32 s34, s34, 1
    s_cmp_lt_u32 s34, 131072
    s_cbranch_scc1 L_a_poll
L_a_poll_done:
    s_mov_b64 exec, -1
    v_pk_add_f32 v[44:45], v[8:9], v[12:13]
    v_pk_add_f32 v[46:47], v[10:11], v[14:15]
    v_pk_add_f32 v[48:49], v[16:17], v[20:21]
    v_pk_add_f32 v[50:51], v[18:19], v[22:23]
    v_pk_add_f32 v[44:45], v[44:45], v[48:49]
    v_pk_add_f32 v[46:47], v[46:47], v[50:51]
    v_lshlrev_b32 v48, 16, v3
    v_and_b32 v49, 0xffff0000, v3
    v_permlane16_swap_b32 v44, v46
    v_permlane16_swap_b32 v45, v47
    v_pk_add_f32 v[44:45], v[44:45], v[46:47]
    v_cvt_pk_bf16_f32 v50, v44, v45
    v_lshlrev_b32 v44, 16, v50
    v_and_b32 v45, 0xffff0000, v50
    v_pk_add_f32 v[44:45], v[44:45], v[48:49]
    v_cvt_pk_bf16_f32 v50, v44, v45
    ds_bpermute_b32 v60, v42, v50
    ds_bpermute_b32 v61, v42, v50 offset:64
    ds_write_b32 v63, v50 offset:8192
    v_lshlrev_b32 v44, 16, v50
    v_and_b32 v45, 0xffff0000, v50
    v_add_f32 v46, v44, v45
    v_mul_f32 v47, v44, v44
    v_fmac_f32 v47, v45, v45
    s_nop 1
    v_permlane16_swap_b32 v46, v47
    v_add_f32 v46, v46, v47
    s_nop 1
    v_add_f32_dpp v46, v46, v46 row_ror:1 row_mask:0xf bank_mask:0xf
    s_nop 1
    v_add_f32_dpp v46, v46, v46 row_ror:2 row_mask:0xf bank_mask:0xf
    s_nop 1
    v_add_f32_dpp v46, v46, v46 row_ror:4 row_mask:0xf bank_mask:0xf
    s_nop 1
    v_add_f32_dpp v46, v46, v46 row_ror:8 row_mask:0xf bank_mask:0xf
    s_mov_b32 exec_lo, 0x00010001
    s_mov_b32 exec_hi, 0x00010001
    ds_write_b32 v1, v46 offset:2048
    s_mov_b64 exec, -1
    s_waitcnt lgkmcnt(2)
    v_mfma_f32_4x4x4_16b_bf16 v[44:47], v[60:61], v[64:65], 0 cbsz:4 abid:0
    v_mfma_f32_4x4x4_16b_bf16 v[48:51], v[60:61], v[66:67], 0 cbsz:4 abid:1
    v_mfma_f32_4x4x4_16b_bf16 v[52:55], v[60:61], v[68:69], 0 cbsz:4 abid:2
    v_mfma_f32_4x4x4_16b_bf16 v[44:47], v[60:61], v[70:71], v[44:47] cbsz:4 abid:3
    v_mfma_f32_4x4x4_16b_bf16 v[48:51], v[60:61], v[72:73], v[48:51] cbsz:4 abid:4
    v_mfma_f32_4x4x4_16b_bf16 v[52:55], v[60:61], v[74:75], v[52:55] cbsz:4 abid:5
    v_mfma_f32_4x4x4_16b_bf16 v[44:47], v[60:61], v[76:77], v[44:47] cbsz:4 abid:6
    v_mfma_f32_4x4x4_16b_bf16 v[48:51], v[60:61], v[78:79], v[48:51] cbsz:4 abid:7
    v_mfma_f32_4x4x4_16b_bf16 v[52:55], v[60:61], v[80:81], v[52:55] cbsz:4 abid:8
    v_mfma_f32_4x4x4_16b_bf16 v[44:47], v[60:61], v[82:83], v[44:47] cbsz:4 abid:9
    v_mfma_f32_4x4x4_16b_bf16 v[48:51], v[60:61], v[84:85], v[48:51] cbsz:4 abid:10
    v_mfma_f32_4x4x4_16b_bf16 v[52:55], v[60:61], v[86:87], v[52:55] cbsz:4 abid:11
    v_mfma_f32_4x4x4_16b_bf16 v[44:47], v[60:61], v[88:89], v[44:47] cbsz:4 abid:12
    v_mfma_f32_4x4x4_16b_bf16 v[48:51], v[60:61], v[90:91], v[48:51] cbsz:4 abid:13
    v_mfma_f32_4x4x4_16b_bf16 v[52:55], v[60:61], v[92:93], v[52:55] cbsz:4 abid:14
    v_mfma_f32_4x4x4_16b_bf16 v[44:47], v[60:61], v[94:95], v[44:47] cbsz:4 abid:15
    s_nop 3
    v_pk_add_f32 v[48:49], v[48:49], v[52:53]
    v_pk_add_f32 v[44:45], v[44:45], v[48:49]
    ds_write2st64_b32 v43, v44, v45 offset0:16 offset1:17
    s_waitcnt vmcnt(0) lgkmcnt(0)
    s_barrier
    ds_read_b128 v[24:27], v2 offset:2048
    ds_read_b128 v[28:31], v2 offset:2064
    ds_read_b128 v[8:11], v40 offset:4096
    ds_read_b128 v[12:15], v40 offset:4608
    ds_read_b128 v[16:19], v40 offset:5120
    ds_read_b128 v[20:23], v40 offset:5632
    s_waitcnt lgkmcnt(4)
    v_pk_add_f32 v[24:25], v[24:25], v[26:27]
    v_pk_add_f32 v[28:29], v[28:29], v[30:31]
    v_pk_add_f32 v[24:25], v[24:25], v[28:29]
    s_nop 1
    v_add_f32_dpp v24, v24, v24 quad_perm:[2,3,0,1] row_mask:0xf bank_mask:0xf
    v_add_f32_dpp v25, v25, v25 quad_perm:[2,3,0,1] row_mask:0xf bank_mask:0xf
    v_mul_f32 v24, 0x3b000000, v24
    v_mul_f32 v25, 0x3b000000, v25
    v_mul_f32 v26, v24, v24
    v_sub_f32 v25, v25, v26
    v_mul_f32 v27, 0x44800000, v25
    v_cmp_ngt_f32 vcc, v27, v26
    s_nop 0
    s_cmp_lg_u64 vcc, 0
    s_cbranch_scc1 L_ln_slow
L_ln_back:
    v_cvt_pk_bf16_f32 v26, v24, v25
    v_and_b32 v25, 0xffff0000, v26
    v_lshlrev_b32 v24, 16, v26
    v_add_f32 v25, 0x3727c5ac, v25
    v_cvt_pk_bf16_f32 v25, v25, v25
    v_and_b32 v25, 0xffff0000, v25
    v_sqrt_f32 v25, v25
    s_waitcnt lgkmcnt(0)
    v_pk_add_f32 v[8:9], v[8:9], v[16:17]
    v_pk_add_f32 v[10:11], v[10:11], v[18:19]
    v_cvt_pk_bf16_f32 v25, v25, v25
    v_pk_add_f32 v[12:13], v[12:13], v[20:21]
    v_and_b32 v25, 0xffff0000, v25
    v_pk_add_f32 v[14:15], v[14:15], v[22:23]
    v_rcp_f32 v26, v25
    v_pk_add_f32 v[8:9], v[8:9], v[12:13]
    v_pk_add_f32 v[10:11], v[10:11], v[14:15]
    s_nop 0
    v_add_f32_dpp v8, v8, v8 quad_perm:[2,3,0,1] row_mask:0xf bank_mask:0xf
    v_add_f32_dpp v9, v9, v9 quad_perm:[2,3,0,1] row_mask:0xf bank_mask:0xf
    v_add_f32_dpp v10, v10, v10 quad_perm:[2,3,0,1] row_mask:0xf bank_mask:0xf
    v_add_f32_dpp v11, v11, v11 quad_perm:[2,3,0,1] row_mask:0xf bank_mask:0xf
    v_pk_fma_f32 v[8:9], v[56:57], v[24:25], v[8:9] op_sel_hi:[1,0,1] neg_lo:[1,0,0] neg_hi:[1,0,0]
    v_pk_fma_f32 v[10:11], v[58:59], v[24:25], v[10:11] op_sel_hi:[1,0,1] neg_lo:[1,0,0] neg_hi:[1,0,0]
    v_pk_mul_f32 v[8:9], v[8:9], v[26:27] op_sel_hi:[1,0]
    v_pk_mul_f32 v[10:11], v[10:11], v[26:27] op_sel_hi:[1,0]
    v_cvt_pk_bf16_f32 v12, v8, v9
    v_cvt_pk_bf16_f32 v13, v10, v11
    v_lshlrev_b32 v8, 16, v12
    v_and_b32 v9, 0xffff0000, v12
    v_lshlrev_b32 v10, 16, v13
    v_and_b32 v11, 0xffff0000, v13
    v_mul_f32 v12, s35, v8
    v_mul_f32 v13, s35, v9
    v_mul_f32 v14, s35, v10
    v_mul_f32 v15, s35, v11
    v_exp_f32 v12, -v12
    v_exp_f32 v13, -v13
    v_exp_f32 v14, -v14
    v_exp_f32 v15, -v15
    v_add_f32 v12, 1.0, v12
    v_add_f32 v13, 1.0, v13
    v_add_f32 v14, 1.0, v14
    v_add_f32 v15, 1.0, v15
    v_rcp_f32 v12, v12
    v_rcp_f32 v13, v13
    v_rcp_f32 v14, v14
    v_rcp_f32 v15, v15
    v_pk_mul_f32 v[8:9], v[8:9], v[12:13]
    v_pk_mul_f32 v[10:11], v[10:11], v[14:15]
    v_cvt_pk_bf16_f32 v60, v8, v9
    v_cvt_pk_bf16_f32 v61, v10, v11
    s_nop 1
    v_mfma_f32_4x4x4_16b_bf16 v[44:47], v[60:61], v[96:97], 0 cbsz:4 abid:0
    v_mfma_f32_4x4x4_16b_bf16 v[48:51], v[60:61], v[98:99], 0 cbsz:4 abid:1
    v_mfma_f32_4x4x4_16b_bf16 v[52:55], v[60:61], v[100:101], 0 cbsz:4 abid:2
    v_mfma_f32_4x4x4_16b_bf16 v[56:59], v[60:61], v[102:103], 0 cbsz:4 abid:3
    v_mfma_f32_4x4x4_16b_bf16 v[44:47], v[60:61], v[104:105], v[44:47] cbsz:4 abid:4
    v_mfma_f32_4x4x4_16b_bf16 v[48:51], v[60:61], v[106:107], v[48:51] cbsz:4 abid:5
    v_mfma_f32_4x4x4_16b_bf16 v[52:55], v[60:61], v[108:109], v[52:55] cbsz:4 abid:6
    v_mfma_f32_4x4x4_16b_bf16 v[56:59], v[60:61], v[110:111], v[56:59] cbsz:4 abid:7
    v_mfma_f32_4x4x4_16b_bf16 v[44:47], v[60:61], v[112:113], v[44:47] cbsz:4 abid:8
    v_mfma_f32_4x4x4_16b_bf16 v[48:51], v[60:61], v[114:115], v[48:51] cbsz:4 abid:9
    v_mfma_f32_4x4x4_16b_bf16 v[52:55], v[60:61], v[116:117], v[52:55] cbsz:4 abid:10
    v_mfma_f32_4x4x4_16b_bf16 v[56:59], v[60:61], v[118:119], v[56:59] cbsz:4 abid:11
    v_mfma_f32_4x4x4_16b_bf16 v[44:47], v[60:61], v[120:121], v[44:47] cbsz:4 abid:12
    v_mfma_f32_4x4x4_16b_bf16 v[48:51], v[60:61], v[122:123], v[48:51] cbsz:4 abid:13
    v_mfma_f32_4x4x4_16b_bf16 v[52:55], v[60:61], v[124:125], v[52:55] cbsz:4 abid:14
    v_mfma_f32_4x4x4_16b_bf16 v[56:59], v[60:61], v[126:127], v[56:59] cbsz:4 abid:15
    s_nop 2
    v_pk_add_f32 v[44:45], v[44:45], v[48:49]
    s_nop 0
    v_pk_add_f32 v[52:53], v[52:53], v[56:57]
    v_pk_add_f32 v[44:45], v[44:45], v[52:53]
    v_lshlrev_b32 v12, 3, v0
    s_lshl_b32 s71, s64, 12
    s_lshl_b32 s72, s26, 9
    s_add_u32 s71, s71, s72
    s_add_u32 s71, s71, 446464
    v_mov_b32_dpp v46, v44 quad_perm:[1,1,3,3] row_mask:0xf bank_mask:0xf
    v_mov_b32_dpp v47, v45 quad_perm:[1,1,3,3] row_mask:0xf bank_mask:0xf
    v_bfi_b32 v44, v41, s30, v44
    v_bfi_b32 v45, v41, s31, v45
    v_bfi_b32 v46, v41, s32, v46
    v_bfi_b32 v47, v41, s33, v47
    s_mov_b32 exec_lo, 0x55555555
    s_mov_b32 exec_hi, 0x55555555
    buffer_store_dwordx4 v[44:47], v12, s[36:39], s71 offen sc1
    s_mov_b64 exec, -1
    s_cmp_ge_u32 s64, 16
    s_cbranch_scc1 L_g_done
    s_lshl_b32 s71, s64, 3
    s_add_u32 s71, s71, s26
    s_lshl_b32 s72, s71, 5
    s_add_u32 s72, s72, 446464
    v_lshrrev_b32 v12, 1, v0
    v_min_u32 v13, 27, v12
    v_lshlrev_b32 v13, 12, v13
    v_lshl_add_u32 v13, v4, 4, v13
    v_cmp_gt_u32 s[12:13], 28, v12
    v_lshrrev_b32 v14, 1, v5
    v_lshlrev_b32 v14, 10, v14
    v_and_b32 v15, 1, v5
    v_lshl_add_u32 v14, v15, 1, v14
    v_lshl_add_u32 v14, v4, 2, v14
    s_lshl_b32 s73, s71, 3
    v_add_u32 v14, s73, v14
    s_mov_b32 s34, 0
    ds_read_u16 v15, v14 offset:8192
L_f_poll:
    buffer_load_dwordx4 v[16:19], v13, s[36:39], s72 offen sc1
    s_waitcnt vmcnt(0)
    v_xor_b32 v16, s30, v16
    v_xor_b32 v17, s31, v17
    v_xor_b32 v18, s32, v18
    v_xor_b32 v19, s33, v19
    v_or3_b32 v40, v16, v17, v18
    v_or_b32 v40, v40, v19
    v_and_b32 v40, 0xff, v40
    v_cmp_ne_u32 vcc, 0, v40
    s_nop 0
    s_cmp_eq_u64 vcc, 0
    s_cbranch_scc1 L_f_poll_done
    s_mov_b64 exec, vcc
    s_add_u32 s34, s34, 1
    s_cmp_lt_u32 s34, 131072
    s_cbranch_scc1 L_f_poll
L_f_poll_done:
    s_mov_b64 exec, -1
    v_cndmask_b32 v8, 0, v16, s[12:13]
    v_cndmask_b32 v9, 0, v17, s[12:13]
    v_cndmask_b32 v10, 0, v18, s[12:13]
    v_cndmask_b32 v11, 0, v19, s[12:13]
    v_permlane32_swap_b32 v8, v9
    s_nop 0
    v_permlane32_swap_b32 v10, v11
    v_add_f32 v8, v8, v9
    v_add_f32 v10, v10, v11
    s_nop 1
    v_permlane16_swap_b32 v8, v10
    v_add_f32 v8, v8, v10
    s_nop 1
    v_add_f32_dpp v8, v8, v8 row_ror:2 row_mask:0xf bank_mask:0xf
    s_nop 1
    v_add_f32_dpp v8, v8, v8 row_ror:4 row_mask:0xf bank_mask:0xf
    s_nop 1
    v_add_f32_dpp v8, v8, v8 row_ror:8 row_mask:0xf bank_mask:0xf
    v_cvt_pk_bf16_f32 v8, v8, v8
    v_and_b32 v8, 0xffff0000, v8
    s_waitcnt lgkmcnt(0)
    v_lshlrev_b32 v15, 16, v15
    v_add_f32 v8, v8, v15
    v_cvt_pk_bf16_f32 v8, v8, v8
    s_mov_b32 exec_lo, 0x00030003
    s_mov_b32 exec_hi, 0x00030003
    buffer_store_short v8, v14, s[60:63], 0 offen
    s_cmp_lg_u32 s71, 0
    s_cbranch_scc1 L_no_epoch
    s_mov_b64 exec, 1
    v_mov_b32 v9, 0
    v_mov_b32 v10, s29
    buffer_store_dword v10, v9, s[36:39], 0 offen
L_no_epoch:
    s_mov_b64 exec, -1
L_g_done:
L_end:
    s_endpgm
L_ln_slow:
    v_lshlrev_b32 v44, 10, v4
    v_lshrrev_b32 v45, 1, v0
    v_lshl_add_u32 v45, v45, 5, v44
    ds_read_b128 v[24:27], v45 offset:8192
    ds_read_b128 v[28:31], v45 offset:8208
    ds_read_b32 v32, v44 offset:8192
    s_waitcnt lgkmcnt(0)
    v_lshlrev_b32 v80, 16, v32
    v_lshlrev_b32 v64, 16, v24
    v_and_b32 v65, 0xffff0000, v24
    v_lshlrev_b32 v66, 16, v25
    v_and_b32 v67, 0xffff0000, v25
    v_lshlrev_b32 v68, 16, v26
    v_and_b32 v69, 0xffff0000, v26
    v_lshlrev_b32 v70, 16, v27
    v_and_b32 v71, 0xffff0000, v27
    v_lshlrev_b32 v72, 16, v28
    v_and_b32 v73, 0xffff0000, v28
    v_lshlrev_b32 v74, 16, v29
    v_and_b32 v75, 0xffff0000, v29
    v_lshlrev_b32 v76, 16, v30
    v_and_b32 v77, 0xffff0000, v30
    v_lshlrev_b32 v78, 16, v31
    v_and_b32 v79, 0xffff0000, v31
    v_pk_add_f32 v[64:65], v[64:65], v[80:81] op_sel_hi:[1,0] neg_lo:[0,1] neg_hi:[0,1]
    v_pk_add_f32 v[66:67], v[66:67], v[80:81] op_sel_hi:[1,0] neg_lo:[0,1] neg_hi:[0,1]
    v_pk_add_f32 v[68:69], v[68:69], v[80:81] op_sel_hi:[1,0] neg_lo:[0,1] neg_hi:[0,1]
    v_pk_add_f32 v[70:71], v[70:71], v[80:81] op_sel_hi:[1,0] neg_lo:[0,1] neg_hi:[0,1]
    v_pk_add_f32 v[72:73], v[72:73], v[80:81] op_sel_hi:[1,0] neg_lo:[0,1] neg_hi:[0,1]
    v_pk_add_f32 v[74:75], v[74:75], v[80:81] op_sel_hi:[1,0] neg_lo:[0,1] neg_hi:[0,1]
    v_pk_add_f32 v[76:77], v[76:77], v[80:81] op_sel_hi:[1,0] neg_lo:[0,1] neg_hi:[0,1]
    v_pk_add_f32 v[78:79], v[78:79], v[80:81] op_sel_hi:[1,0] neg_lo:[0,1] neg_hi:[0,1]
    v_pk_add_f32 v[82:83], v[64:65], v[66:67]
    v_pk_mul_f32 v[84:85], v[64:65], v[64:65]
    v_pk_fma_f32 v[84:85], v[66:67], v[66:67], v[84:85]
    v_pk_add_f32 v[82:83], v[82:83], v[68:69]
    v_pk_fma_f32 v[84:85], v[68:69], v[68:69], v[84:85]
    v_pk_add_f32 v[82:83], v[82:83], v[70:71]
    v_pk_fma_f32 v[84:85], v[70:71], v[70:71], v[84:85]
    v_pk_add_f32 v[82:83], v[82:83], v[72:73]
    v_pk_fma_f32 v[84:85], v[72:73], v[72:73], v[84:85]
    v_pk_add_f32 v[82:83], v[82:83], v[74:75]
    v_pk_fma_f32 v[84:85], v[74:75], v[74:75], v[84:85]
    v_pk_add_f32 v[82:83], v[82:83], v[76:77]
    v_pk_fma_f32 v[84:85], v[76:77], v[76:77], v[84:85]
    v_pk_add_f32 v[82:83], v[82:83], v[78:79]
    v_pk_fma_f32 v[84:85], v[78:79], v[78:79], v[84:85]
    v_add_f32 v82, v82, v83
    v_add_f32 v84, v84, v85
    s_nop 1
    v_permlane32_swap_b32 v82, v84
    v_add_f32 v82, v82, v84
    s_nop 1
    v_add_f32_dpp v82, v82, v82 row_ror:2 row_mask:0xf bank_mask:0xf
    s_nop 1
    v_add_f32_dpp v82, v82, v82 row_ror:4 row_mask:0xf bank_mask:0xf
    s_nop 1
    v_add_f32_dpp v82, v82, v82 row_ror:8 row_mask:0xf bank_mask:0xf
    v_mov_b32 v84, v82
    s_nop 1
    v_permlane16_swap_b32 v82, v84
    v_add_f32 v82, v82, v84
    v_mul_f32 v82, 0x3b000000, v82
    v_mov_b32 v84, v82
    s_nop 1
    v_permlane32_swap_b32 v82, v84
    v_fma_f32 v84, -v82, v82, v84
    v_add_f32 v82, v82, v80
    v_max_f32 v84, 0, v84
    v_mov_b32 v24, v82
    v_mov_b32 v25, v84
    s_branch L_ln_back
L_code_end:
.section .rodata,"a"
.p2align 6
.amdhsa_kernel sequential_preLN__sliding_block_cached__dense_activation_silu__decode_kernel
  .amdhsa_next_free_vgpr 128
  .amdhsa_next_free_sgpr 102
  .amdhsa_accum_offset 128
  .amdhsa_group_segment_fixed_size 0
  .amdhsa_kernarg_size 88
  .amdhsa_user_sgpr_count 2
  .amdhsa_user_sgpr_kernarg_segment_ptr 1
  .amdhsa_system_sgpr_workgroup_id_x 1
.end_amdhsa_kernel
```
